```python
import torch

def _softmax(x, axis=-1):
    return torch.softmax(x, dim=axis)
def _gelu(x):
    return torch.nn.functional.gelu(x, approximate="tanh")
def _silu(x):
    return torch.nn.functional.silu(x)
def _sigmoid(x):
    return torch.sigmoid(x)
def _layernorm(x, axis=-1, eps=1e-5):
    m = x.mean(dim=axis, keepdim=True)
    v = x.var(dim=axis, keepdim=True, unbiased=False)
    return (x - m) / torch.sqrt(v + eps)
def _scatter_add(tgt, idx, src, axis=0):
    return tgt.clone().index_add_(axis, idx, src)
def _segment_sum(src, seg, n):
    out = torch.zeros((n,) + src.shape[1:], dtype=src.dtype)
    return out.index_add_(0, seg, src)
def _pad(x, pw):
    flat = tuple(v for pair in reversed(pw) for v in pair)
    return torch.nn.functional.pad(x, flat)

kernel_name = 'sequential_preLN__mha_block__moe_arch_mod__prompt'

def setup_inputs():

    _w = (lambda a: (lambda t: t.to(torch.bfloat16) if t.is_floating_point() else t)(torch.as_tensor(a)))
    def _A_setup():
        B, S, D, H = 1, 2048, 512, 32
        return {
            "x": _w((lambda *s: torch.randn(*s, dtype=torch.bfloat16) * 0.05)(B, S, D)),
            "wqkv": _w((lambda *s: torch.randn(*s, dtype=torch.bfloat16) * 0.05)(D, 3 * D)),
            "wo": _w((lambda *s: torch.randn(*s, dtype=torch.bfloat16) * 0.05)(D, D)),
        }
    _A_in = _A_setup()

    def _B_setup():
        B, S, D, F, C = 1, 2048, 512, 1376, 8
        return {
            "x": _w((lambda *s: torch.randn(*s, dtype=torch.bfloat16) * 0.05)(B, S, D)),
            "w_r": _w((lambda *s: torch.randn(*s, dtype=torch.bfloat16) * 0.05)(D)),
            "w_gate": _w((lambda *s: torch.randn(*s, dtype=torch.bfloat16) * 0.05)(D, F)),
            "w_up": _w((lambda *s: torch.randn(*s, dtype=torch.bfloat16) * 0.05)(D, F)),
            "w_down": _w((lambda *s: torch.randn(*s, dtype=torch.bfloat16) * 0.05)(F, D)),
        }
    _B_in = _B_setup()

    return {
        "A_x": _A_in["x"],
        "A_wqkv": _A_in["wqkv"],
        "A_wo": _A_in["wo"],
        "B_x": _B_in["x"],
        "B_w_r": _B_in["w_r"],
        "B_w_gate": _B_in["w_gate"],
        "B_w_up": _B_in["w_up"],
        "B_w_down": _B_in["w_down"],
    }

def reference(A_x, A_wqkv, A_wo, B_x, B_w_r, B_w_gate, B_w_up, B_w_down):
    def _A_ref(x, wqkv, wo):
        B, S, D = x.shape
        H = 32
        Dh = D // H
        qkv = (lambda x, *d: x.permute(*d))((x @ wqkv).reshape(B, S, 3, H, Dh), 2, 0, 3, 1, 4)
        q, k, v = qkv[0], qkv[1], qkv[2]
        scores = torch.einsum("bhqd,bhkd->bhqk", q, k) * (Dh ** -0.5)
        p = _softmax(scores, axis=-1)
        o = torch.einsum("bhqk,bhkd->bhqd", p, v)
        return (lambda x, *d: x.permute(*d))(o, 0, 2, 1, 3).reshape(B, S, D) @ wo

    def _B_ref(x, w_r, w_gate, w_up, w_down):
        B, S, D = x.shape
        C = 8
        r = x @ w_r
        idx = torch.argsort(-r, axis=-1)[:, :C]
        idx_e = (lambda x, n, axis: torch.repeat_interleave(x, n, dim=axis))(idx.reshape(B, C, 1), D, axis=2)
        x_sel = (lambda x, i, axis: torch.take_along_dim(x, i, dim=axis))(x, idx_e, axis=1)
        g = _silu(x_sel @ w_gate)
        u = x_sel @ w_up
        y = (g * u) @ w_down
        r_sel = _sigmoid((lambda x, i, axis: torch.take_along_dim(x, i, dim=axis))(r, idx, axis=1))
        y = y * r_sel.reshape(B, C, 1)
        b_off = (torch.arange(B) * S).reshape(B, 1)
        flat_idx = (idx + b_off).reshape(B * C)
        zero = (x * 0.0).reshape(B * S, D)
        upd = _scatter_add(zero, flat_idx, y.reshape(B * C, D), axis=0)
        return x + upd.reshape(B, S, D)

    x = A_x
    h = x + _A_ref(_layernorm(x, axis=-1), A_wqkv, A_wo)
    h2 = h + _B_ref(_layernorm(h, axis=-1), B_w_r, B_w_gate, B_w_up, B_w_down)
    return h2
```

```asm
; @launch grid=(256,1,1) block=(576,1,1) lds=163840
.amdgcn_target "amdgcn-amd-amdhsa--gfx950"
.text
.globl sequential_preLN__mha_block__moe_arch_mod__prompt_kernel
.p2align 8
.type sequential_preLN__mha_block__moe_arch_mod__prompt_kernel,@function
sequential_preLN__mha_block__moe_arch_mod__prompt_kernel:
text_start:
  s_cmp_ge_u32 s2, 256
  s_cbranch_scc1 K_end0
  s_load_dwordx4 s[4:7], s[0:1], 0
  s_load_dwordx4 s[56:59], s[0:1], 72
  s_getpc_b64 s[52:53]
K_pc:
  s_sub_u32 s52, s52, K_pc-text_start
  s_subb_u32 s53, s53, 0
  v_lshlrev_b32 v104, 7, v0
  v_min_u32 v104, text_end-text_start-4, v104
  global_load_dword v144, v104, s[52:53]
  v_lshrrev_b32 v2, 6, v0
  v_and_b32 v1, 63, v0
  s_and_b32 s10, s2, 7
  v_readfirstlane_b32 s20, v2
  s_lshr_b32 s11, s2, 3
  s_lshr_b32 s21, s11, 1
  s_lshl_b32 s22, s10, 1
  s_and_b32 s3, s11, 1
  s_add_u32 s22, s22, s3
  s_and_b32 s43, s20, 3
  s_lshl_b32 s23, s21, 2
  s_add_u32 s23, s23, s43
  s_lshl_b32 s30, s43, 14
  s_add_u32 s30, s30, 98304
  s_lshl_b32 s47, s22, 18
  s_add_u32 s47, s47, 2097152
  s_sub_u32 s61, 255, s2
  s_and_b32 s3, s61, 7
  s_mul_i32 s33, s3, 11
  s_lshr_b32 s62, s61, 3
  s_add_u32 s33, s33, s62
  s_cmp_eq_u32 s3, 7
  s_subb_u32 s33, s33, 0
  s_sub_u32 s62, s61, 87
  s_and_b32 s3, s62, 7
  s_lshl_b32 s3, s3, 2
  s_lshr_b32 s63, s62, 3
  s_add_u32 s3, s3, s63
  s_add_u32 s3, s3, 87
  s_cmp_lt_u32 s62, 32
  s_cselect_b32 s3, s3, s61
  s_cmp_lt_u32 s61, 86
  s_cselect_b32 s61, s33, s3
  s_cmp_eq_u32 s20, 8
  s_cbranch_scc1 K_stream
  s_branch K_go
K_end0:
  s_endpgm
K_go:
  v_and_b32 v104, 31, v1
  v_lshrrev_b32 v105, 5, v1
  v_bfe_u32 v106, v1, 1, 3
  v_xor_b32 v106, v106, v105
  v_lshlrev_b32 v106, 4, v106
  v_lshl_add_u32 v106, v104, 7, v106
  v_xor_b32 v4, 0, v106
  v_add_u32 v4, s30, v4
  v_xor_b32 v5, 32, v106
  v_add_u32 v5, s30, v5
  v_xor_b32 v6, 64, v106
  v_add_u32 v6, s30, v6
  v_xor_b32 v7, 96, v106
  v_add_u32 v7, s30, v7
  v_lshlrev_b32 v107, 3, v105
  v_bfe_u32 v2, v1, 2, 2
  v_add_u32 v107, v107, v2
  v_mul_u32_u24 v107, 192, v107
  v_bfe_u32 v2, v1, 4, 1
  v_lshl_add_u32 v107, v2, 5, v107
  v_and_b32 v2, 3, v1
  v_lshl_add_u32 v8, v2, 3, v107
  s_lshl_b32 s28, s23, 15
  s_lshl_b32 s29, s22, 6
  s_mul_i32 s31, s43, 3072
  s_mul_i32 s3, s43, 192
  s_mov_b32 s32, 43691
  v_add_u32 v2, s3, v1
  v_mul_lo_u32 v104, v2, s32
  v_lshrrev_b32 v104, 19, v104
  v_mul_u32_u24 v105, 12, v104
  v_sub_u32 v105, v2, v105
  v_mul_u32_u24 v104, 3072, v104
  v_lshrrev_b32 v106, 2, v105
  v_lshl_add_u32 v104, v106, 10, v104
  v_and_b32 v105, 3, v105
  v_lshl_add_u32 v10, v105, 4, v104
  v_add_u32 v2, s3, v1
  v_add_u32 v2, 64, v2
  v_mul_lo_u32 v104, v2, s32
  v_lshrrev_b32 v104, 19, v104
  v_mul_u32_u24 v105, 12, v104
  v_sub_u32 v105, v2, v105
  v_mul_u32_u24 v104, 3072, v104
  v_lshrrev_b32 v106, 2, v105
  v_lshl_add_u32 v104, v106, 10, v104
  v_and_b32 v105, 3, v105
  v_lshl_add_u32 v11, v105, 4, v104
  v_add_u32 v2, s3, v1
  v_add_u32 v2, 128, v2
  v_mul_lo_u32 v104, v2, s32
  v_lshrrev_b32 v104, 19, v104
  v_mul_u32_u24 v105, 12, v104
  v_sub_u32 v105, v2, v105
  v_mul_u32_u24 v104, 3072, v104
  v_lshrrev_b32 v106, 2, v105
  v_lshl_add_u32 v104, v106, 10, v104
  v_and_b32 v105, 3, v105
  v_lshl_add_u32 v12, v105, 4, v104
  v_lshrrev_b32 v104, 3, v1
  v_lshlrev_b32 v104, 10, v104
  v_lshrrev_b32 v105, 4, v1
  v_and_b32 v106, 7, v1
  v_xor_b32 v105, v105, v106
  v_lshl_add_u32 v13, v105, 4, v104
  v_xor_b32 v2, 4, v105
  v_lshl_add_u32 v14, v2, 4, v104
  v_add_u32 v14, 8192, v14
  v_lshl_add_u32 v15, v105, 4, v104
  v_add_u32 v15, 16384, v15
  v_xor_b32 v2, 4, v105
  v_lshl_add_u32 v16, v2, 4, v104
  v_add_u32 v16, 24576, v16
  s_lshr_b32 s45, s11, 1
  s_and_b32 s3, s11, 1
  s_lshl_b32 s3, s3, 2
  s_add_u32 s45, s45, s3
  s_waitcnt lgkmcnt(0)
  s_mov_b32 s12, s4
  s_mov_b32 s13, s5
  s_mov_b32 s14, 2097152
  s_mov_b32 s15, 0x20000
  s_mov_b32 s16, s6
  s_mov_b32 s17, s7
  s_mov_b32 s18, 1572864
  s_mov_b32 s19, 0x20000
  s_cmp_lt_u32 s20, 4
  s_cbranch_scc1 K_compute
  v_mov_b32 v17, v8
  v_add_u32 v18, 49152, v8
  s_min_u32 s3, s43, 2
  s_lshl_b32 s3, s3, 6
  v_add_u32 v8, s3, v8
  v_add_u32 v9, 49152, v8
  v_lshrrev_b32 v2, 1, v1
  v_xor_b32 v2, v2, v1
  v_and_b32 v2, 8, v2
  v_cmp_eq_u32 vcc, 0, v2
  v_mov_b32 v76, 0x3f803f80
  v_mov_b32 v24, 0
  v_mov_b32 v28, 0
  v_mov_b32 v72, 0
  v_mov_b32 v25, 0
  v_mov_b32 v29, 0
  v_mov_b32 v73, 0
  v_mov_b32 v26, 0
  v_mov_b32 v30, 0
  v_mov_b32 v74, 0
  v_mov_b32 v27, 0
  v_mov_b32 v31, 0
  v_mov_b32 v75, 0
  v_cndmask_b32 v20, 0, v76, vcc
  v_cndmask_b32 v21, 0, v76, vcc
  v_cndmask_b32 v22, 0, v76, vcc
  v_cndmask_b32 v23, 0, v76, vcc
  v_mov_b32 v112, 0
  v_mov_b32 v113, 0
  v_mov_b32 v114, 0
  v_mov_b32 v115, 0
  v_mov_b32 v116, 0
  v_mov_b32 v117, 0
  v_mov_b32 v118, 0
  v_mov_b32 v119, 0
  v_mov_b32 v120, 0
  v_mov_b32 v121, 0
  v_mov_b32 v122, 0
  v_mov_b32 v123, 0
  v_mov_b32 v124, 0
  v_mov_b32 v125, 0
  v_mov_b32 v126, 0
  v_mov_b32 v127, 0
  s_barrier
  ds_read_b128 v[32:35], v4 offset:0
  ds_read_b128 v[36:39], v5 offset:0
  ds_read_b128 v[40:43], v6 offset:0
  ds_read_b128 v[44:47], v7 offset:0
  ds_read_b64_tr_b16 v[56:57], v8 offset:0
  ds_read_b64_tr_b16 v[58:59], v8 offset:768
  ds_read_b64_tr_b16 v[60:61], v8 offset:3072
  ds_read_b64_tr_b16 v[62:63], v8 offset:3840
  ds_read_b64_tr_b16 v[64:65], v8 offset:6144
  ds_read_b64_tr_b16 v[66:67], v8 offset:6912
  ds_read_b64_tr_b16 v[68:69], v8 offset:9216
  ds_read_b64_tr_b16 v[70:71], v8 offset:9984
  ds_read_b64_tr_b16 v[80:81], v17 offset:0
  ds_read_b64_tr_b16 v[82:83], v17 offset:768
  ds_read_b64_tr_b16 v[84:85], v17 offset:3072
  ds_read_b64_tr_b16 v[86:87], v17 offset:3840
  ds_read_b64_tr_b16 v[88:89], v17 offset:6144
  ds_read_b64_tr_b16 v[90:91], v17 offset:6912
  ds_read_b64_tr_b16 v[92:93], v17 offset:9216
  ds_read_b64_tr_b16 v[94:95], v17 offset:9984
  s_waitcnt lgkmcnt(8)
  v_dot2_f32_bf16 v24, v32, v76, v24
  v_dot2_f32_bf16 v28, v32, v32, v28
  v_dot2_f32_bf16 v25, v33, v76, v25
  v_dot2_f32_bf16 v29, v33, v33, v29
  v_dot2_f32_bf16 v26, v34, v76, v26
  v_dot2_f32_bf16 v30, v34, v34, v30
  v_dot2_f32_bf16 v27, v35, v76, v27
  v_dot2_f32_bf16 v31, v35, v35, v31
  v_dot2_f32_bf16 v24, v36, v76, v24
  v_dot2_f32_bf16 v28, v36, v36, v28
  v_dot2_f32_bf16 v25, v37, v76, v25
  v_dot2_f32_bf16 v29, v37, v37, v29
  v_dot2_f32_bf16 v26, v38, v76, v26
  v_dot2_f32_bf16 v30, v38, v38, v30
  v_dot2_f32_bf16 v27, v39, v76, v27
  v_dot2_f32_bf16 v31, v39, v39, v31
  v_dot2_f32_bf16 v24, v40, v76, v24
  v_dot2_f32_bf16 v28, v40, v40, v28
  v_dot2_f32_bf16 v25, v41, v76, v25
  v_dot2_f32_bf16 v29, v41, v41, v29
  v_dot2_f32_bf16 v26, v42, v76, v26
  v_dot2_f32_bf16 v30, v42, v42, v30
  v_dot2_f32_bf16 v27, v43, v76, v27
  v_dot2_f32_bf16 v31, v43, v43, v31
  v_dot2_f32_bf16 v24, v44, v76, v24
  v_dot2_f32_bf16 v28, v44, v44, v28
  v_dot2_f32_bf16 v25, v45, v76, v25
  v_dot2_f32_bf16 v29, v45, v45, v29
  v_dot2_f32_bf16 v26, v46, v76, v26
  v_dot2_f32_bf16 v30, v46, v46, v30
  v_dot2_f32_bf16 v27, v47, v76, v27
  v_dot2_f32_bf16 v31, v47, v47, v31
  s_waitcnt lgkmcnt(0)
  v_mfma_f32_16x16x32_bf16 v[72:75], v[56:59], v[20:23], v[72:75]
  v_mfma_f32_32x32x16_bf16 v[112:127], v[80:83], v[32:35], v[112:127]
  v_mfma_f32_16x16x32_bf16 v[72:75], v[60:63], v[20:23], v[72:75]
  v_mfma_f32_32x32x16_bf16 v[112:127], v[84:87], v[36:39], v[112:127]
  v_mfma_f32_16x16x32_bf16 v[72:75], v[64:67], v[20:23], v[72:75]
  v_mfma_f32_32x32x16_bf16 v[112:127], v[88:91], v[40:43], v[112:127]
  v_mfma_f32_16x16x32_bf16 v[72:75], v[68:71], v[20:23], v[72:75]
  v_mfma_f32_32x32x16_bf16 v[112:127], v[92:95], v[44:47], v[112:127]
  s_barrier
  ds_read_b128 v[32:35], v4 offset:4096
  ds_read_b128 v[36:39], v5 offset:4096
  ds_read_b128 v[40:43], v6 offset:4096
  ds_read_b128 v[44:47], v7 offset:4096
  ds_read_b64_tr_b16 v[56:57], v8 offset:12288
  ds_read_b64_tr_b16 v[58:59], v8 offset:13056
  ds_read_b64_tr_b16 v[60:61], v8 offset:15360
  ds_read_b64_tr_b16 v[62:63], v8 offset:16128
  ds_read_b64_tr_b16 v[64:65], v8 offset:18432
  ds_read_b64_tr_b16 v[66:67], v8 offset:19200
  ds_read_b64_tr_b16 v[68:69], v8 offset:21504
  ds_read_b64_tr_b16 v[70:71], v8 offset:22272
  ds_read_b64_tr_b16 v[80:81], v17 offset:12288
  ds_read_b64_tr_b16 v[82:83], v17 offset:13056
  ds_read_b64_tr_b16 v[84:85], v17 offset:15360
  ds_read_b64_tr_b16 v[86:87], v17 offset:16128
  ds_read_b64_tr_b16 v[88:89], v17 offset:18432
  ds_read_b64_tr_b16 v[90:91], v17 offset:19200
  ds_read_b64_tr_b16 v[92:93], v17 offset:21504
  ds_read_b64_tr_b16 v[94:95], v17 offset:22272
  s_waitcnt lgkmcnt(8)
  v_dot2_f32_bf16 v24, v32, v76, v24
  v_dot2_f32_bf16 v28, v32, v32, v28
  v_dot2_f32_bf16 v25, v33, v76, v25
  v_dot2_f32_bf16 v29, v33, v33, v29
  v_dot2_f32_bf16 v26, v34, v76, v26
  v_dot2_f32_bf16 v30, v34, v34, v30
  v_dot2_f32_bf16 v27, v35, v76, v27
  v_dot2_f32_bf16 v31, v35, v35, v31
  v_dot2_f32_bf16 v24, v36, v76, v24
  v_dot2_f32_bf16 v28, v36, v36, v28
  v_dot2_f32_bf16 v25, v37, v76, v25
  v_dot2_f32_bf16 v29, v37, v37, v29
  v_dot2_f32_bf16 v26, v38, v76, v26
  v_dot2_f32_bf16 v30, v38, v38, v30
  v_dot2_f32_bf16 v27, v39, v76, v27
  v_dot2_f32_bf16 v31, v39, v39, v31
  v_dot2_f32_bf16 v24, v40, v76, v24
  v_dot2_f32_bf16 v28, v40, v40, v28
  v_dot2_f32_bf16 v25, v41, v76, v25
  v_dot2_f32_bf16 v29, v41, v41, v29
  v_dot2_f32_bf16 v26, v42, v76, v26
  v_dot2_f32_bf16 v30, v42, v42, v30
  v_dot2_f32_bf16 v27, v43, v76, v27
  v_dot2_f32_bf16 v31, v43, v43, v31
  v_dot2_f32_bf16 v24, v44, v76, v24
  v_dot2_f32_bf16 v28, v44, v44, v28
  v_dot2_f32_bf16 v25, v45, v76, v25
  v_dot2_f32_bf16 v29, v45, v45, v29
  v_dot2_f32_bf16 v26, v46, v76, v26
  v_dot2_f32_bf16 v30, v46, v46, v30
  v_dot2_f32_bf16 v27, v47, v76, v27
  v_dot2_f32_bf16 v31, v47, v47, v31
  s_waitcnt lgkmcnt(0)
  v_mfma_f32_16x16x32_bf16 v[72:75], v[56:59], v[20:23], v[72:75]
  v_mfma_f32_32x32x16_bf16 v[112:127], v[80:83], v[32:35], v[112:127]
  v_mfma_f32_16x16x32_bf16 v[72:75], v[60:63], v[20:23], v[72:75]
  v_mfma_f32_32x32x16_bf16 v[112:127], v[84:87], v[36:39], v[112:127]
  v_mfma_f32_16x16x32_bf16 v[72:75], v[64:67], v[20:23], v[72:75]
  v_mfma_f32_32x32x16_bf16 v[112:127], v[88:91], v[40:43], v[112:127]
  v_mfma_f32_16x16x32_bf16 v[72:75], v[68:71], v[20:23], v[72:75]
  v_mfma_f32_32x32x16_bf16 v[112:127], v[92:95], v[44:47], v[112:127]
  s_barrier
  ds_read_b128 v[32:35], v4 offset:8192
  ds_read_b128 v[36:39], v5 offset:8192
  ds_read_b128 v[40:43], v6 offset:8192
  ds_read_b128 v[44:47], v7 offset:8192
  ds_read_b64_tr_b16 v[56:57], v8 offset:24576
  ds_read_b64_tr_b16 v[58:59], v8 offset:25344
  ds_read_b64_tr_b16 v[60:61], v8 offset:27648
  ds_read_b64_tr_b16 v[62:63], v8 offset:28416
  ds_read_b64_tr_b16 v[64:65], v8 offset:30720
  ds_read_b64_tr_b16 v[66:67], v8 offset:31488
  ds_read_b64_tr_b16 v[68:69], v8 offset:33792
  ds_read_b64_tr_b16 v[70:71], v8 offset:34560
  ds_read_b64_tr_b16 v[80:81], v17 offset:24576
  ds_read_b64_tr_b16 v[82:83], v17 offset:25344
  ds_read_b64_tr_b16 v[84:85], v17 offset:27648
  ds_read_b64_tr_b16 v[86:87], v17 offset:28416
  ds_read_b64_tr_b16 v[88:89], v17 offset:30720
  ds_read_b64_tr_b16 v[90:91], v17 offset:31488
  ds_read_b64_tr_b16 v[92:93], v17 offset:33792
  ds_read_b64_tr_b16 v[94:95], v17 offset:34560
  s_waitcnt lgkmcnt(8)
  v_dot2_f32_bf16 v24, v32, v76, v24
  v_dot2_f32_bf16 v28, v32, v32, v28
  v_dot2_f32_bf16 v25, v33, v76, v25
  v_dot2_f32_bf16 v29, v33, v33, v29
  v_dot2_f32_bf16 v26, v34, v76, v26
  v_dot2_f32_bf16 v30, v34, v34, v30
  v_dot2_f32_bf16 v27, v35, v76, v27
  v_dot2_f32_bf16 v31, v35, v35, v31
  v_dot2_f32_bf16 v24, v36, v76, v24
  v_dot2_f32_bf16 v28, v36, v36, v28
  v_dot2_f32_bf16 v25, v37, v76, v25
  v_dot2_f32_bf16 v29, v37, v37, v29
  v_dot2_f32_bf16 v26, v38, v76, v26
  v_dot2_f32_bf16 v30, v38, v38, v30
  v_dot2_f32_bf16 v27, v39, v76, v27
  v_dot2_f32_bf16 v31, v39, v39, v31
  v_dot2_f32_bf16 v24, v40, v76, v24
  v_dot2_f32_bf16 v28, v40, v40, v28
  v_dot2_f32_bf16 v25, v41, v76, v25
  v_dot2_f32_bf16 v29, v41, v41, v29
  v_dot2_f32_bf16 v26, v42, v76, v26
  v_dot2_f32_bf16 v30, v42, v42, v30
  v_dot2_f32_bf16 v27, v43, v76, v27
  v_dot2_f32_bf16 v31, v43, v43, v31
  v_dot2_f32_bf16 v24, v44, v76, v24
  v_dot2_f32_bf16 v28, v44, v44, v28
  v_dot2_f32_bf16 v25, v45, v76, v25
  v_dot2_f32_bf16 v29, v45, v45, v29
  v_dot2_f32_bf16 v26, v46, v76, v26
  v_dot2_f32_bf16 v30, v46, v46, v30
  v_dot2_f32_bf16 v27, v47, v76, v27
  v_dot2_f32_bf16 v31, v47, v47, v31
  s_waitcnt lgkmcnt(0)
  v_mfma_f32_16x16x32_bf16 v[72:75], v[56:59], v[20:23], v[72:75]
  v_mfma_f32_32x32x16_bf16 v[112:127], v[80:83], v[32:35], v[112:127]
  v_mfma_f32_16x16x32_bf16 v[72:75], v[60:63], v[20:23], v[72:75]
  v_mfma_f32_32x32x16_bf16 v[112:127], v[84:87], v[36:39], v[112:127]
  v_mfma_f32_16x16x32_bf16 v[72:75], v[64:67], v[20:23], v[72:75]
  v_mfma_f32_32x32x16_bf16 v[112:127], v[88:91], v[40:43], v[112:127]
  v_mfma_f32_16x16x32_bf16 v[72:75], v[68:71], v[20:23], v[72:75]
  v_mfma_f32_32x32x16_bf16 v[112:127], v[92:95], v[44:47], v[112:127]
  s_barrier
  ds_read_b128 v[32:35], v4 offset:12288
  ds_read_b128 v[36:39], v5 offset:12288
  ds_read_b128 v[40:43], v6 offset:12288
  ds_read_b128 v[44:47], v7 offset:12288
  ds_read_b64_tr_b16 v[56:57], v8 offset:36864
  ds_read_b64_tr_b16 v[58:59], v8 offset:37632
  ds_read_b64_tr_b16 v[60:61], v8 offset:39936
  ds_read_b64_tr_b16 v[62:63], v8 offset:40704
  ds_read_b64_tr_b16 v[64:65], v8 offset:43008
  ds_read_b64_tr_b16 v[66:67], v8 offset:43776
  ds_read_b64_tr_b16 v[68:69], v8 offset:46080
  ds_read_b64_tr_b16 v[70:71], v8 offset:46848
  ds_read_b64_tr_b16 v[80:81], v17 offset:36864
  ds_read_b64_tr_b16 v[82:83], v17 offset:37632
  ds_read_b64_tr_b16 v[84:85], v17 offset:39936
  ds_read_b64_tr_b16 v[86:87], v17 offset:40704
  ds_read_b64_tr_b16 v[88:89], v17 offset:43008
  ds_read_b64_tr_b16 v[90:91], v17 offset:43776
  ds_read_b64_tr_b16 v[92:93], v17 offset:46080
  ds_read_b64_tr_b16 v[94:95], v17 offset:46848
  s_waitcnt lgkmcnt(8)
  v_dot2_f32_bf16 v24, v32, v76, v24
  v_dot2_f32_bf16 v28, v32, v32, v28
  v_dot2_f32_bf16 v25, v33, v76, v25
  v_dot2_f32_bf16 v29, v33, v33, v29
  v_dot2_f32_bf16 v26, v34, v76, v26
  v_dot2_f32_bf16 v30, v34, v34, v30
  v_dot2_f32_bf16 v27, v35, v76, v27
  v_dot2_f32_bf16 v31, v35, v35, v31
  v_dot2_f32_bf16 v24, v36, v76, v24
  v_dot2_f32_bf16 v28, v36, v36, v28
  v_dot2_f32_bf16 v25, v37, v76, v25
  v_dot2_f32_bf16 v29, v37, v37, v29
  v_dot2_f32_bf16 v26, v38, v76, v26
  v_dot2_f32_bf16 v30, v38, v38, v30
  v_dot2_f32_bf16 v27, v39, v76, v27
  v_dot2_f32_bf16 v31, v39, v39, v31
  v_dot2_f32_bf16 v24, v40, v76, v24
  v_dot2_f32_bf16 v28, v40, v40, v28
  v_dot2_f32_bf16 v25, v41, v76, v25
  v_dot2_f32_bf16 v29, v41, v41, v29
  v_dot2_f32_bf16 v26, v42, v76, v26
  v_dot2_f32_bf16 v30, v42, v42, v30
  v_dot2_f32_bf16 v27, v43, v76, v27
  v_dot2_f32_bf16 v31, v43, v43, v31
  v_dot2_f32_bf16 v24, v44, v76, v24
  v_dot2_f32_bf16 v28, v44, v44, v28
  v_dot2_f32_bf16 v25, v45, v76, v25
  v_dot2_f32_bf16 v29, v45, v45, v29
  v_dot2_f32_bf16 v26, v46, v76, v26
  v_dot2_f32_bf16 v30, v46, v46, v30
  v_dot2_f32_bf16 v27, v47, v76, v27
  v_dot2_f32_bf16 v31, v47, v47, v31
  s_waitcnt lgkmcnt(0)
  v_mfma_f32_16x16x32_bf16 v[72:75], v[56:59], v[20:23], v[72:75]
  v_mfma_f32_32x32x16_bf16 v[112:127], v[80:83], v[32:35], v[112:127]
  v_mfma_f32_16x16x32_bf16 v[72:75], v[60:63], v[20:23], v[72:75]
  v_mfma_f32_32x32x16_bf16 v[112:127], v[84:87], v[36:39], v[112:127]
  v_mfma_f32_16x16x32_bf16 v[72:75], v[64:67], v[20:23], v[72:75]
  v_mfma_f32_32x32x16_bf16 v[112:127], v[88:91], v[40:43], v[112:127]
  v_mfma_f32_16x16x32_bf16 v[72:75], v[68:71], v[20:23], v[72:75]
  v_mfma_f32_32x32x16_bf16 v[112:127], v[92:95], v[44:47], v[112:127]
  s_barrier
  ds_read_b128 v[32:35], v4 offset:0
  ds_read_b128 v[36:39], v5 offset:0
  ds_read_b128 v[40:43], v6 offset:0
  ds_read_b128 v[44:47], v7 offset:0
  ds_read_b64_tr_b16 v[56:57], v9 offset:0
  ds_read_b64_tr_b16 v[58:59], v9 offset:768
  ds_read_b64_tr_b16 v[60:61], v9 offset:3072
  ds_read_b64_tr_b16 v[62:63], v9 offset:3840
  ds_read_b64_tr_b16 v[64:65], v9 offset:6144
  ds_read_b64_tr_b16 v[66:67], v9 offset:6912
  ds_read_b64_tr_b16 v[68:69], v9 offset:9216
  ds_read_b64_tr_b16 v[70:71], v9 offset:9984
  s_waitcnt lgkmcnt(8)
  v_dot2_f32_bf16 v24, v32, v76, v24
  v_dot2_f32_bf16 v28, v32, v32, v28
  v_dot2_f32_bf16 v25, v33, v76, v25
  v_dot2_f32_bf16 v29, v33, v33, v29
  v_dot2_f32_bf16 v26, v34, v76, v26
  v_dot2_f32_bf16 v30, v34, v34, v30
  v_dot2_f32_bf16 v27, v35, v76, v27
  v_dot2_f32_bf16 v31, v35, v35, v31
  v_dot2_f32_bf16 v24, v36, v76, v24
  v_dot2_f32_bf16 v28, v36, v36, v28
  v_dot2_f32_bf16 v25, v37, v76, v25
  v_dot2_f32_bf16 v29, v37, v37, v29
  v_dot2_f32_bf16 v26, v38, v76, v26
  v_dot2_f32_bf16 v30, v38, v38, v30
  v_dot2_f32_bf16 v27, v39, v76, v27
  v_dot2_f32_bf16 v31, v39, v39, v31
  v_dot2_f32_bf16 v24, v40, v76, v24
  v_dot2_f32_bf16 v28, v40, v40, v28
  v_dot2_f32_bf16 v25, v41, v76, v25
  v_dot2_f32_bf16 v29, v41, v41, v29
  v_dot2_f32_bf16 v26, v42, v76, v26
  v_dot2_f32_bf16 v30, v42, v42, v30
  v_dot2_f32_bf16 v27, v43, v76, v27
  v_dot2_f32_bf16 v31, v43, v43, v31
  v_dot2_f32_bf16 v24, v44, v76, v24
  v_dot2_f32_bf16 v28, v44, v44, v28
  v_dot2_f32_bf16 v25, v45, v76, v25
  v_dot2_f32_bf16 v29, v45, v45, v29
  v_dot2_f32_bf16 v26, v46, v76, v26
  v_dot2_f32_bf16 v30, v46, v46, v30
  v_dot2_f32_bf16 v27, v47, v76, v27
  v_dot2_f32_bf16 v31, v47, v47, v31
  s_waitcnt lgkmcnt(0)
  v_mfma_f32_16x16x32_bf16 v[72:75], v[56:59], v[20:23], v[72:75]
  v_mfma_f32_16x16x32_bf16 v[72:75], v[60:63], v[20:23], v[72:75]
  v_mfma_f32_16x16x32_bf16 v[72:75], v[64:67], v[20:23], v[72:75]
  v_mfma_f32_16x16x32_bf16 v[72:75], v[68:71], v[20:23], v[72:75]
  s_barrier
  ds_read_b128 v[32:35], v4 offset:4096
  ds_read_b128 v[36:39], v5 offset:4096
  ds_read_b128 v[40:43], v6 offset:4096
  ds_read_b128 v[44:47], v7 offset:4096
  ds_read_b64_tr_b16 v[56:57], v9 offset:12288
  ds_read_b64_tr_b16 v[58:59], v9 offset:13056
  ds_read_b64_tr_b16 v[60:61], v9 offset:15360
  ds_read_b64_tr_b16 v[62:63], v9 offset:16128
  ds_read_b64_tr_b16 v[64:65], v9 offset:18432
  ds_read_b64_tr_b16 v[66:67], v9 offset:19200
  ds_read_b64_tr_b16 v[68:69], v9 offset:21504
  ds_read_b64_tr_b16 v[70:71], v9 offset:22272
  s_waitcnt lgkmcnt(8)
  v_dot2_f32_bf16 v24, v32, v76, v24
  v_dot2_f32_bf16 v28, v32, v32, v28
  v_dot2_f32_bf16 v25, v33, v76, v25
  v_dot2_f32_bf16 v29, v33, v33, v29
  v_dot2_f32_bf16 v26, v34, v76, v26
  v_dot2_f32_bf16 v30, v34, v34, v30
  v_dot2_f32_bf16 v27, v35, v76, v27
  v_dot2_f32_bf16 v31, v35, v35, v31
  v_dot2_f32_bf16 v24, v36, v76, v24
  v_dot2_f32_bf16 v28, v36, v36, v28
  v_dot2_f32_bf16 v25, v37, v76, v25
  v_dot2_f32_bf16 v29, v37, v37, v29
  v_dot2_f32_bf16 v26, v38, v76, v26
  v_dot2_f32_bf16 v30, v38, v38, v30
  v_dot2_f32_bf16 v27, v39, v76, v27
  v_dot2_f32_bf16 v31, v39, v39, v31
  v_dot2_f32_bf16 v24, v40, v76, v24
  v_dot2_f32_bf16 v28, v40, v40, v28
  v_dot2_f32_bf16 v25, v41, v76, v25
  v_dot2_f32_bf16 v29, v41, v41, v29
  v_dot2_f32_bf16 v26, v42, v76, v26
  v_dot2_f32_bf16 v30, v42, v42, v30
  v_dot2_f32_bf16 v27, v43, v76, v27
  v_dot2_f32_bf16 v31, v43, v43, v31
  v_dot2_f32_bf16 v24, v44, v76, v24
  v_dot2_f32_bf16 v28, v44, v44, v28
  v_dot2_f32_bf16 v25, v45, v76, v25
  v_dot2_f32_bf16 v29, v45, v45, v29
  v_dot2_f32_bf16 v26, v46, v76, v26
  v_dot2_f32_bf16 v30, v46, v46, v30
  v_dot2_f32_bf16 v27, v47, v76, v27
  v_dot2_f32_bf16 v31, v47, v47, v31
  s_waitcnt lgkmcnt(0)
  v_mfma_f32_16x16x32_bf16 v[72:75], v[56:59], v[20:23], v[72:75]
  v_mfma_f32_16x16x32_bf16 v[72:75], v[60:63], v[20:23], v[72:75]
  v_mfma_f32_16x16x32_bf16 v[72:75], v[64:67], v[20:23], v[72:75]
  v_mfma_f32_16x16x32_bf16 v[72:75], v[68:71], v[20:23], v[72:75]
  s_barrier
  ds_read_b128 v[32:35], v4 offset:8192
  ds_read_b128 v[36:39], v5 offset:8192
  ds_read_b128 v[40:43], v6 offset:8192
  ds_read_b128 v[44:47], v7 offset:8192
  ds_read_b64_tr_b16 v[56:57], v9 offset:24576
  ds_read_b64_tr_b16 v[58:59], v9 offset:25344
  ds_read_b64_tr_b16 v[60:61], v9 offset:27648
  ds_read_b64_tr_b16 v[62:63], v9 offset:28416
  ds_read_b64_tr_b16 v[64:65], v9 offset:30720
  ds_read_b64_tr_b16 v[66:67], v9 offset:31488
  ds_read_b64_tr_b16 v[68:69], v9 offset:33792
  ds_read_b64_tr_b16 v[70:71], v9 offset:34560
  s_waitcnt lgkmcnt(8)
  v_dot2_f32_bf16 v24, v32, v76, v24
  v_dot2_f32_bf16 v28, v32, v32, v28
  v_dot2_f32_bf16 v25, v33, v76, v25
  v_dot2_f32_bf16 v29, v33, v33, v29
  v_dot2_f32_bf16 v26, v34, v76, v26
  v_dot2_f32_bf16 v30, v34, v34, v30
  v_dot2_f32_bf16 v27, v35, v76, v27
  v_dot2_f32_bf16 v31, v35, v35, v31
  v_dot2_f32_bf16 v24, v36, v76, v24
  v_dot2_f32_bf16 v28, v36, v36, v28
  v_dot2_f32_bf16 v25, v37, v76, v25
  v_dot2_f32_bf16 v29, v37, v37, v29
  v_dot2_f32_bf16 v26, v38, v76, v26
  v_dot2_f32_bf16 v30, v38, v38, v30
  v_dot2_f32_bf16 v27, v39, v76, v27
  v_dot2_f32_bf16 v31, v39, v39, v31
  v_dot2_f32_bf16 v24, v40, v76, v24
  v_dot2_f32_bf16 v28, v40, v40, v28
  v_dot2_f32_bf16 v25, v41, v76, v25
  v_dot2_f32_bf16 v29, v41, v41, v29
  v_dot2_f32_bf16 v26, v42, v76, v26
  v_dot2_f32_bf16 v30, v42, v42, v30
  v_dot2_f32_bf16 v27, v43, v76, v27
  v_dot2_f32_bf16 v31, v43, v43, v31
  v_dot2_f32_bf16 v24, v44, v76, v24
  v_dot2_f32_bf16 v28, v44, v44, v28
  v_dot2_f32_bf16 v25, v45, v76, v25
  v_dot2_f32_bf16 v29, v45, v45, v29
  v_dot2_f32_bf16 v26, v46, v76, v26
  v_dot2_f32_bf16 v30, v46, v46, v30
  v_dot2_f32_bf16 v27, v47, v76, v27
  v_dot2_f32_bf16 v31, v47, v47, v31
  s_waitcnt lgkmcnt(0)
  v_mfma_f32_16x16x32_bf16 v[72:75], v[56:59], v[20:23], v[72:75]
  v_mfma_f32_16x16x32_bf16 v[72:75], v[60:63], v[20:23], v[72:75]
  v_mfma_f32_16x16x32_bf16 v[72:75], v[64:67], v[20:23], v[72:75]
  v_mfma_f32_16x16x32_bf16 v[72:75], v[68:71], v[20:23], v[72:75]
  s_barrier
  ds_read_b128 v[32:35], v4 offset:12288
  ds_read_b128 v[36:39], v5 offset:12288
  ds_read_b128 v[40:43], v6 offset:12288
  ds_read_b128 v[44:47], v7 offset:12288
  ds_read_b64_tr_b16 v[56:57], v9 offset:36864
  ds_read_b64_tr_b16 v[58:59], v9 offset:37632
  ds_read_b64_tr_b16 v[60:61], v9 offset:39936
  ds_read_b64_tr_b16 v[62:63], v9 offset:40704
  ds_read_b64_tr_b16 v[64:65], v9 offset:43008
  ds_read_b64_tr_b16 v[66:67], v9 offset:43776
  ds_read_b64_tr_b16 v[68:69], v9 offset:46080
  ds_read_b64_tr_b16 v[70:71], v9 offset:46848
  s_waitcnt lgkmcnt(8)
  v_dot2_f32_bf16 v24, v32, v76, v24
  v_dot2_f32_bf16 v28, v32, v32, v28
  v_dot2_f32_bf16 v25, v33, v76, v25
  v_dot2_f32_bf16 v29, v33, v33, v29
  v_dot2_f32_bf16 v26, v34, v76, v26
  v_dot2_f32_bf16 v30, v34, v34, v30
  v_dot2_f32_bf16 v27, v35, v76, v27
  v_dot2_f32_bf16 v31, v35, v35, v31
  v_dot2_f32_bf16 v24, v36, v76, v24
  v_dot2_f32_bf16 v28, v36, v36, v28
  v_dot2_f32_bf16 v25, v37, v76, v25
  v_dot2_f32_bf16 v29, v37, v37, v29
  v_dot2_f32_bf16 v26, v38, v76, v26
  v_dot2_f32_bf16 v30, v38, v38, v30
  v_dot2_f32_bf16 v27, v39, v76, v27
  v_dot2_f32_bf16 v31, v39, v39, v31
  v_dot2_f32_bf16 v24, v40, v76, v24
  v_dot2_f32_bf16 v28, v40, v40, v28
  v_dot2_f32_bf16 v25, v41, v76, v25
  v_dot2_f32_bf16 v29, v41, v41, v29
  v_dot2_f32_bf16 v26, v42, v76, v26
  v_dot2_f32_bf16 v30, v42, v42, v30
  v_dot2_f32_bf16 v27, v43, v76, v27
  v_dot2_f32_bf16 v31, v43, v43, v31
  v_dot2_f32_bf16 v24, v44, v76, v24
  v_dot2_f32_bf16 v28, v44, v44, v28
  v_dot2_f32_bf16 v25, v45, v76, v25
  v_dot2_f32_bf16 v29, v45, v45, v29
  v_dot2_f32_bf16 v26, v46, v76, v26
  v_dot2_f32_bf16 v30, v46, v46, v30
  v_dot2_f32_bf16 v27, v47, v76, v27
  v_dot2_f32_bf16 v31, v47, v47, v31
  s_waitcnt lgkmcnt(0)
  v_mfma_f32_16x16x32_bf16 v[72:75], v[56:59], v[20:23], v[72:75]
  v_mfma_f32_16x16x32_bf16 v[72:75], v[60:63], v[20:23], v[72:75]
  v_mfma_f32_16x16x32_bf16 v[72:75], v[64:67], v[20:23], v[72:75]
  v_mfma_f32_16x16x32_bf16 v[72:75], v[68:71], v[20:23], v[72:75]
  v_add_f32 v24, v24, v25
  v_add_f32 v26, v26, v27
  v_add_f32 v24, v24, v26
  v_mov_b32 v25, v24
  v_add_f32 v28, v28, v29
  v_add_f32 v30, v30, v31
  v_add_f32 v28, v28, v30
  v_mov_b32 v29, v28
  s_nop 1
  v_permlane32_swap_b32 v24, v25
  v_permlane32_swap_b32 v28, v29
  s_nop 1
  v_add_f32 v24, v24, v25
  v_add_f32 v28, v28, v29
  v_mul_f32 v24, 0x3b000000, v24
  v_mul_f32 v28, 0x3b000000, v28
  v_fma_f32 v28, -v24, v24, v28
  v_max_f32 v28, 0, v28
  v_cvt_pk_bf16_f32 v24, v24, v24
  v_lshlrev_b32 v24, 16, v24
  v_cvt_pk_bf16_f32 v28, v28, v28
  v_lshlrev_b32 v28, 16, v28
  v_add_f32 v28, 0x3727c5ac, v28
  v_cvt_pk_bf16_f32 v28, v28, v28
  v_lshlrev_b32 v28, 16, v28
  v_sqrt_f32 v28, v28
  s_lshl_b32 s3, s43, 8
  s_add_u32 s3, s3, 512
  v_cvt_pk_bf16_f32 v28, v28, v28
  v_lshlrev_b32 v28, 16, v28
  v_rcp_f32 v28, v28
  v_lshlrev_b32 v2, 2, v1
  v_add_u32 v2, s3, v2
  v_cmp_lt_u32 vcc, 31, v1
  v_lshrrev_b32 v105, 4, v1
  s_lshl_b32 s3, s43, 7
  s_add_u32 s3, s3, 0
  v_cndmask_b32 v25, v24, v28, vcc
  v_lshlrev_b32 v105, 4, v105
  v_bfe_u32 v106, v1, 3, 1
  v_lshl_add_u32 v105, v106, 6, v105
  v_add_u32 v105, s3, v105
  ds_write_b32 v2, v25
  s_mov_b32 s40, 0x01010101
  s_mov_b32 s41, 0x01010101
  s_mov_b64 exec, s[40:41]
  ds_write_b128 v105, v[72:75]
  s_mov_b64 exec, -1
  s_mov_b32 s24, s58
  s_mov_b32 s25, s59
  s_mov_b32 s26, 13631488
  s_mov_b32 s27, 0x20000
  s_waitcnt lgkmcnt(0)
  s_barrier
  ds_read_b128 v[32:35], v4 offset:0
  ds_read_b64_tr_b16 v[56:57], v18 offset:0
  ds_read_b64_tr_b16 v[58:59], v18 offset:768
  ds_read_b128 v[36:39], v5 offset:0
  ds_read_b64_tr_b16 v[60:61], v18 offset:3072
  ds_read_b64_tr_b16 v[62:63], v18 offset:3840
  ds_read_b128 v[40:43], v6 offset:0
  ds_read_b64_tr_b16 v[64:65], v18 offset:6144
  ds_read_b64_tr_b16 v[66:67], v18 offset:6912
  ds_read_b128 v[44:47], v7 offset:0
  ds_read_b64_tr_b16 v[68:69], v18 offset:9216
  ds_read_b64_tr_b16 v[70:71], v18 offset:9984
  s_waitcnt lgkmcnt(9)
  v_mfma_f32_32x32x16_bf16 v[112:127], v[56:59], v[32:35], v[112:127]
  ds_read_b128 v[128:131], v4 offset:4096
  ds_read_b64_tr_b16 v[80:81], v18 offset:12288
  ds_read_b64_tr_b16 v[82:83], v18 offset:13056
  s_waitcnt lgkmcnt(9)
  v_mfma_f32_32x32x16_bf16 v[112:127], v[60:63], v[36:39], v[112:127]
  ds_read_b128 v[132:135], v5 offset:4096
  ds_read_b64_tr_b16 v[84:85], v18 offset:15360
  ds_read_b64_tr_b16 v[86:87], v18 offset:16128
  s_waitcnt lgkmcnt(9)
  v_mfma_f32_32x32x16_bf16 v[112:127], v[64:67], v[40:43], v[112:127]
  ds_read_b128 v[136:139], v6 offset:4096
  ds_read_b64_tr_b16 v[88:89], v18 offset:18432
  ds_read_b64_tr_b16 v[90:91], v18 offset:19200
  s_waitcnt lgkmcnt(9)
  v_mfma_f32_32x32x16_bf16 v[112:127], v[68:71], v[44:47], v[112:127]
  ds_read_b128 v[140:143], v7 offset:4096
  ds_read_b64_tr_b16 v[92:93], v18 offset:21504
  ds_read_b64_tr_b16 v[94:95], v18 offset:22272
  s_waitcnt lgkmcnt(9)
  v_mfma_f32_32x32x16_bf16 v[112:127], v[80:83], v[128:131], v[112:127]
  ds_read_b128 v[32:35], v4 offset:8192
  ds_read_b64_tr_b16 v[56:57], v18 offset:24576
  ds_read_b64_tr_b16 v[58:59], v18 offset:25344
  s_waitcnt lgkmcnt(9)
  v_mfma_f32_32x32x16_bf16 v[112:127], v[84:87], v[132:135], v[112:127]
  ds_read_b128 v[36:39], v5 offset:8192
  ds_read_b64_tr_b16 v[60:61], v18 offset:27648
  ds_read_b64_tr_b16 v[62:63], v18 offset:28416
  s_waitcnt lgkmcnt(9)
  v_mfma_f32_32x32x16_bf16 v[112:127], v[88:91], v[136:139], v[112:127]
  ds_read_b128 v[40:43], v6 offset:8192
  ds_read_b64_tr_b16 v[64:65], v18 offset:30720
  ds_read_b64_tr_b16 v[66:67], v18 offset:31488
  s_waitcnt lgkmcnt(9)
  v_mfma_f32_32x32x16_bf16 v[112:127], v[92:95], v[140:143], v[112:127]
  ds_read_b128 v[44:47], v7 offset:8192
  ds_read_b64_tr_b16 v[68:69], v18 offset:33792
  ds_read_b64_tr_b16 v[70:71], v18 offset:34560
  s_waitcnt lgkmcnt(9)
  v_mfma_f32_32x32x16_bf16 v[112:127], v[56:59], v[32:35], v[112:127]
  ds_read_b128 v[128:131], v4 offset:12288
  ds_read_b64_tr_b16 v[80:81], v18 offset:36864
  ds_read_b64_tr_b16 v[82:83], v18 offset:37632
  s_waitcnt lgkmcnt(9)
  v_mfma_f32_32x32x16_bf16 v[112:127], v[60:63], v[36:39], v[112:127]
  ds_read_b128 v[132:135], v5 offset:12288
  ds_read_b64_tr_b16 v[84:85], v18 offset:39936
  ds_read_b64_tr_b16 v[86:87], v18 offset:40704
  s_waitcnt lgkmcnt(9)
  v_mfma_f32_32x32x16_bf16 v[112:127], v[64:67], v[40:43], v[112:127]
  ds_read_b128 v[136:139], v6 offset:12288
  ds_read_b64_tr_b16 v[88:89], v18 offset:43008
  ds_read_b64_tr_b16 v[90:91], v18 offset:43776
  s_waitcnt lgkmcnt(9)
  v_mfma_f32_32x32x16_bf16 v[112:127], v[68:71], v[44:47], v[112:127]
  ds_read_b128 v[140:143], v7 offset:12288
  ds_read_b64_tr_b16 v[92:93], v18 offset:46080
  ds_read_b64_tr_b16 v[94:95], v18 offset:46848
  s_waitcnt lgkmcnt(9)
  v_mfma_f32_32x32x16_bf16 v[112:127], v[80:83], v[128:131], v[112:127]
  s_waitcnt lgkmcnt(6)
  v_mfma_f32_32x32x16_bf16 v[112:127], v[84:87], v[132:135], v[112:127]
  s_waitcnt lgkmcnt(3)
  v_mfma_f32_32x32x16_bf16 v[112:127], v[88:91], v[136:139], v[112:127]
  s_waitcnt lgkmcnt(0)
  v_mfma_f32_32x32x16_bf16 v[112:127], v[92:95], v[140:143], v[112:127]
  v_lshrrev_b32 v105, 5, v1
  v_lshlrev_b32 v105, 4, v105
  ds_read_b128 v[32:35], v105 offset:0
  ds_read_b128 v[36:39], v105 offset:32
  ds_read_b128 v[40:43], v105 offset:64
  ds_read_b128 v[44:47], v105 offset:96
  v_mul_f32 v28, 0x3eb8aa3b, v28
  v_lshlrev_b32 v2, 4, v1
  s_lshl_b32 s3, s43, 10
  s_add_u32 s3, s3, 4096
  v_add_u32 v2, s3, v2
  s_nop 4
  s_waitcnt lgkmcnt(0)
  v_fma_f32 v112, -v24, v32, v112
  v_fma_f32 v113, -v24, v33, v113
  v_fma_f32 v114, -v24, v34, v114
  v_fma_f32 v115, -v24, v35, v115
  v_fma_f32 v116, -v24, v36, v116
  v_fma_f32 v117, -v24, v37, v117
  v_fma_f32 v118, -v24, v38, v118
  v_fma_f32 v119, -v24, v39, v119
  v_fma_f32 v120, -v24, v40, v120
  v_fma_f32 v121, -v24, v41, v121
  v_fma_f32 v122, -v24, v42, v122
  v_fma_f32 v123, -v24, v43, v123
  v_fma_f32 v124, -v24, v44, v124
  v_fma_f32 v125, -v24, v45, v125
  v_fma_f32 v126, -v24, v46, v126
  v_fma_f32 v127, -v24, v47, v127
  v_mul_f32 v112, v28, v112
  v_mul_f32 v113, v28, v113
  v_mul_f32 v114, v28, v114
  v_mul_f32 v115, v28, v115
  v_mul_f32 v116, v28, v116
  v_mul_f32 v117, v28, v117
  v_mul_f32 v118, v28, v118
  v_mul_f32 v119, v28, v119
  v_mul_f32 v120, v28, v120
  v_mul_f32 v121, v28, v121
  v_mul_f32 v122, v28, v122
  v_mul_f32 v123, v28, v123
  v_mul_f32 v124, v28, v124
  v_mul_f32 v125, v28, v125
  v_mul_f32 v126, v28, v126
  v_mul_f32 v127, v28, v127
  v_cvt_pk_bf16_f32 v32, v112, v113
  v_cvt_pk_bf16_f32 v33, v114, v115
  v_cvt_pk_bf16_f32 v34, v116, v117
  v_cvt_pk_bf16_f32 v35, v118, v119
  ds_write_b128 v2, v[32:35]
  v_cvt_pk_bf16_f32 v96, v120, v121
  v_cvt_pk_bf16_f32 v97, v122, v123
  v_cvt_pk_bf16_f32 v98, v124, v125
  v_cvt_pk_bf16_f32 v99, v126, v127
  s_waitcnt lgkmcnt(0)
  s_mov_b32 s60, 1
  s_barrier
  s_branch K_attn
K_compute:
  s_add_u32 s46, s45, 0
  s_and_b32 s46, s46, 7
  s_lshl_b32 s33, s46, 7
  s_add_u32 s33, s33, s28
  s_add_u32 m0, s30, 0
  s_nop 0
  buffer_load_dwordx4 v13, s[12:15], s33 offen lds
  s_add_u32 m0, s30, 1024
  s_nop 0
  buffer_load_dwordx4 v14, s[12:15], s33 offen lds
  s_add_u32 m0, s30, 2048
  s_nop 0
  buffer_load_dwordx4 v15, s[12:15], s33 offen lds
  s_add_u32 m0, s30, 3072
  s_nop 0
  buffer_load_dwordx4 v16, s[12:15], s33 offen lds
  s_mul_i32 s32, s46, 196608
  s_add_u32 s32, s32, s29
  s_add_u32 m0, s31, 0
  s_nop 0
  buffer_load_dwordx4 v10, s[16:19], s32 offen lds
  s_add_u32 m0, s31, 1024
  s_nop 0
  buffer_load_dwordx4 v11, s[16:19], s32 offen lds
  s_add_u32 m0, s31, 2048
  s_nop 0
  buffer_load_dwordx4 v12, s[16:19], s32 offen lds
  s_add_u32 s46, s45, 1
  s_and_b32 s46, s46, 7
  s_lshl_b32 s33, s46, 7
  s_add_u32 s33, s33, s28
  s_add_u32 m0, s30, 4096
  s_nop 0
  buffer_load_dwordx4 v13, s[12:15], s33 offen lds
  s_add_u32 m0, s30, 5120
  s_nop 0
  buffer_load_dwordx4 v14, s[12:15], s33 offen lds
  s_add_u32 m0, s30, 6144
  s_nop 0
  buffer_load_dwordx4 v15, s[12:15], s33 offen lds
  s_add_u32 m0, s30, 7168
  s_nop 0
  buffer_load_dwordx4 v16, s[12:15], s33 offen lds
  s_mul_i32 s32, s46, 196608
  s_add_u32 s32, s32, s29
  s_add_u32 m0, s31, 12288
  s_nop 0
  buffer_load_dwordx4 v10, s[16:19], s32 offen lds
  s_add_u32 m0, s31, 13312
  s_nop 0
  buffer_load_dwordx4 v11, s[16:19], s32 offen lds
  s_add_u32 m0, s31, 14336
  s_nop 0
  buffer_load_dwordx4 v12, s[16:19], s32 offen lds
  v_add_u32 v9, 49152, v8
  v_mov_b32 v56, 0
  v_mov_b32 v57, 0
  v_mov_b32 v58, 0
  v_mov_b32 v59, 0
  v_mov_b32 v60, 0
  v_mov_b32 v61, 0
  v_mov_b32 v62, 0
  v_mov_b32 v63, 0
  v_mov_b32 v64, 0
  v_mov_b32 v65, 0
  v_mov_b32 v66, 0
  v_mov_b32 v67, 0
  v_mov_b32 v68, 0
  v_mov_b32 v69, 0
  v_mov_b32 v70, 0
  v_mov_b32 v71, 0
  v_mov_b32 v72, 0
  v_mov_b32 v73, 0
  v_mov_b32 v74, 0
  v_mov_b32 v75, 0
  v_mov_b32 v76, 0
  v_mov_b32 v77, 0
  v_mov_b32 v78, 0
  v_mov_b32 v79, 0
  v_mov_b32 v80, 0
  v_mov_b32 v81, 0
  v_mov_b32 v82, 0
  v_mov_b32 v83, 0
  v_mov_b32 v84, 0
  v_mov_b32 v85, 0
  v_mov_b32 v86, 0
  v_mov_b32 v87, 0
  v_mov_b32 v88, 0
  v_mov_b32 v89, 0
  v_mov_b32 v90, 0
  v_mov_b32 v91, 0
  v_mov_b32 v92, 0
  v_mov_b32 v93, 0
  v_mov_b32 v94, 0
  v_mov_b32 v95, 0
  v_mov_b32 v96, 0
  v_mov_b32 v97, 0
  v_mov_b32 v98, 0
  v_mov_b32 v99, 0
  v_mov_b32 v100, 0
  v_mov_b32 v101, 0
  v_mov_b32 v102, 0
  v_mov_b32 v103, 0
  s_waitcnt lgkmcnt(0)
  s_mov_b32 s24, s58
  s_mov_b32 s25, s59
  s_mov_b32 s26, 13631488
  s_mov_b32 s27, 0x20000
  s_waitcnt vmcnt(7)
  s_barrier
  ds_read_b128 v[24:27], v4 offset:0
  ds_read_b64_tr_b16 v[36:37], v8 offset:64
  ds_read_b64_tr_b16 v[38:39], v8 offset:832
  ds_read_b64_tr_b16 v[40:41], v8 offset:128
  ds_read_b64_tr_b16 v[42:43], v8 offset:896
  s_waitcnt lgkmcnt(2)
  v_mfma_f32_32x32x16_bf16 v[72:87], v[36:39], v[24:27], v[72:87]
  ds_read_b128 v[28:31], v5 offset:0
  ds_read_b64_tr_b16 v[48:49], v8 offset:3136
  ds_read_b64_tr_b16 v[50:51], v8 offset:3904
  s_add_u32 s46, s45, 2
  s_and_b32 s46, s46, 7
  s_lshl_b32 s33, s46, 7
  s_add_u32 s33, s33, s28
  s_add_u32 m0, s30, 8192
  s_nop 0
  buffer_load_dwordx4 v13, s[12:15], s33 offen lds
  s_waitcnt lgkmcnt(3)
  v_mfma_f32_32x32x16_bf16 v[88:103], v[24:27], v[40:43], v[88:103]
  ds_read_b64_tr_b16 v[52:53], v8 offset:3200
  ds_read_b64_tr_b16 v[54:55], v8 offset:3968
  s_add_u32 m0, s30, 9216
  s_nop 0
  buffer_load_dwordx4 v14, s[12:15], s33 offen lds
  s_waitcnt lgkmcnt(2)
  v_mfma_f32_32x32x16_bf16 v[72:87], v[48:51], v[28:31], v[72:87]
  ds_read_b128 v[24:27], v6 offset:0
  ds_read_b64_tr_b16 v[36:37], v8 offset:6208
  ds_read_b64_tr_b16 v[38:39], v8 offset:6976
  s_add_u32 m0, s30, 10240
  s_nop 0
  buffer_load_dwordx4 v15, s[12:15], s33 offen lds
  s_waitcnt lgkmcnt(3)
  v_mfma_f32_32x32x16_bf16 v[88:103], v[28:31], v[52:55], v[88:103]
  ds_read_b64_tr_b16 v[40:41], v8 offset:6272
  ds_read_b64_tr_b16 v[42:43], v8 offset:7040
  s_add_u32 m0, s30, 11264
  s_nop 0
  buffer_load_dwordx4 v16, s[12:15], s33 offen lds
  s_waitcnt lgkmcnt(2)
  v_mfma_f32_32x32x16_bf16 v[72:87], v[36:39], v[24:27], v[72:87]
  ds_read_b128 v[28:31], v7 offset:0
  ds_read_b64_tr_b16 v[48:49], v8 offset:9280
  ds_read_b64_tr_b16 v[50:51], v8 offset:10048
  s_mul_i32 s32, s46, 196608
  s_add_u32 s32, s32, s29
  s_add_u32 m0, s31, 24576
  s_nop 0
  buffer_load_dwordx4 v10, s[16:19], s32 offen lds
  s_waitcnt lgkmcnt(3)
  v_mfma_f32_32x32x16_bf16 v[88:103], v[24:27], v[40:43], v[88:103]
  ds_read_b64_tr_b16 v[52:53], v8 offset:9344
  ds_read_b64_tr_b16 v[54:55], v8 offset:10112
  s_add_u32 m0, s31, 25600
  s_nop 0
  buffer_load_dwordx4 v11, s[16:19], s32 offen lds
  s_waitcnt lgkmcnt(2)
  v_mfma_f32_32x32x16_bf16 v[72:87], v[48:51], v[28:31], v[72:87]
  s_add_u32 m0, s31, 26624
  s_nop 0
  buffer_load_dwordx4 v12, s[16:19], s32 offen lds
  s_waitcnt lgkmcnt(0)
  v_mfma_f32_32x32x16_bf16 v[88:103], v[28:31], v[52:55], v[88:103]
  s_waitcnt vmcnt(7)
  s_barrier
  ds_read_b128 v[24:27], v4 offset:4096
  ds_read_b64_tr_b16 v[36:37], v8 offset:12352
  ds_read_b64_tr_b16 v[38:39], v8 offset:13120
  ds_read_b64_tr_b16 v[40:41], v8 offset:12416
  ds_read_b64_tr_b16 v[42:43], v8 offset:13184
  s_waitcnt lgkmcnt(2)
  v_mfma_f32_32x32x16_bf16 v[72:87], v[36:39], v[24:27], v[72:87]
  ds_read_b128 v[28:31], v5 offset:4096
  ds_read_b64_tr_b16 v[48:49], v8 offset:15424
  ds_read_b64_tr_b16 v[50:51], v8 offset:16192
  s_add_u32 s46, s45, 3
  s_and_b32 s46, s46, 7
  s_lshl_b32 s33, s46, 7
  s_add_u32 s33, s33, s28
  s_add_u32 m0, s30, 12288
  s_nop 0
  buffer_load_dwordx4 v13, s[12:15], s33 offen lds
  s_waitcnt lgkmcnt(3)
  v_mfma_f32_32x32x16_bf16 v[88:103], v[24:27], v[40:43], v[88:103]
  ds_read_b64_tr_b16 v[52:53], v8 offset:15488
  ds_read_b64_tr_b16 v[54:55], v8 offset:16256
  s_add_u32 m0, s30, 13312
  s_nop 0
  buffer_load_dwordx4 v14, s[12:15], s33 offen lds
  s_waitcnt lgkmcnt(2)
  v_mfma_f32_32x32x16_bf16 v[72:87], v[48:51], v[28:31], v[72:87]
  ds_read_b128 v[24:27], v6 offset:4096
  ds_read_b64_tr_b16 v[36:37], v8 offset:18496
  ds_read_b64_tr_b16 v[38:39], v8 offset:19264
  s_add_u32 m0, s30, 14336
  s_nop 0
  buffer_load_dwordx4 v15, s[12:15], s33 offen lds
  s_waitcnt lgkmcnt(3)
  v_mfma_f32_32x32x16_bf16 v[88:103], v[28:31], v[52:55], v[88:103]
  ds_read_b64_tr_b16 v[40:41], v8 offset:18560
  ds_read_b64_tr_b16 v[42:43], v8 offset:19328
  s_add_u32 m0, s30, 15360
  s_nop 0
  buffer_load_dwordx4 v16, s[12:15], s33 offen lds
  s_waitcnt lgkmcnt(2)
  v_mfma_f32_32x32x16_bf16 v[72:87], v[36:39], v[24:27], v[72:87]
  ds_read_b128 v[28:31], v7 offset:4096
  ds_read_b64_tr_b16 v[48:49], v8 offset:21568
  ds_read_b64_tr_b16 v[50:51], v8 offset:22336
  s_mul_i32 s32, s46, 196608
  s_add_u32 s32, s32, s29
  s_add_u32 m0, s31, 36864
  s_nop 0
  buffer_load_dwordx4 v10, s[16:19], s32 offen lds
  s_waitcnt lgkmcnt(3)
  v_mfma_f32_32x32x16_bf16 v[88:103], v[24:27], v[40:43], v[88:103]
  ds_read_b64_tr_b16 v[52:53], v8 offset:21632
  ds_read_b64_tr_b16 v[54:55], v8 offset:22400
  s_add_u32 m0, s31, 37888
  s_nop 0
  buffer_load_dwordx4 v11, s[16:19], s32 offen lds
  s_waitcnt lgkmcnt(2)
  v_mfma_f32_32x32x16_bf16 v[72:87], v[48:51], v[28:31], v[72:87]
  s_add_u32 m0, s31, 38912
  s_nop 0
  buffer_load_dwordx4 v12, s[16:19], s32 offen lds
  s_waitcnt lgkmcnt(0)
  v_mfma_f32_32x32x16_bf16 v[88:103], v[28:31], v[52:55], v[88:103]
  s_waitcnt vmcnt(7)
  s_barrier
  ds_read_b128 v[24:27], v4 offset:8192
  ds_read_b64_tr_b16 v[36:37], v8 offset:24640
  ds_read_b64_tr_b16 v[38:39], v8 offset:25408
  ds_read_b64_tr_b16 v[40:41], v8 offset:24704
  ds_read_b64_tr_b16 v[42:43], v8 offset:25472
  s_waitcnt lgkmcnt(2)
  v_mfma_f32_32x32x16_bf16 v[72:87], v[36:39], v[24:27], v[72:87]
  ds_read_b128 v[28:31], v5 offset:8192
  ds_read_b64_tr_b16 v[48:49], v8 offset:27712
  ds_read_b64_tr_b16 v[50:51], v8 offset:28480
  s_add_u32 s46, s45, 4
  s_and_b32 s46, s46, 7
  s_lshl_b32 s33, s46, 7
  s_add_u32 s33, s33, s28
  s_add_u32 m0, s30, 0
  s_nop 0
  buffer_load_dwordx4 v13, s[12:15], s33 offen lds
  s_waitcnt lgkmcnt(3)
  v_mfma_f32_32x32x16_bf16 v[88:103], v[24:27], v[40:43], v[88:103]
  ds_read_b64_tr_b16 v[52:53], v8 offset:27776
  ds_read_b64_tr_b16 v[54:55], v8 offset:28544
  s_add_u32 m0, s30, 1024
  s_nop 0
  buffer_load_dwordx4 v14, s[12:15], s33 offen lds
  s_waitcnt lgkmcnt(2)
  v_mfma_f32_32x32x16_bf16 v[72:87], v[48:51], v[28:31], v[72:87]
  ds_read_b128 v[24:27], v6 offset:8192
  ds_read_b64_tr_b16 v[36:37], v8 offset:30784
  ds_read_b64_tr_b16 v[38:39], v8 offset:31552
  s_add_u32 m0, s30, 2048
  s_nop 0
  buffer_load_dwordx4 v15, s[12:15], s33 offen lds
  s_waitcnt lgkmcnt(3)
  v_mfma_f32_32x32x16_bf16 v[88:103], v[28:31], v[52:55], v[88:103]
  ds_read_b64_tr_b16 v[40:41], v8 offset:30848
  ds_read_b64_tr_b16 v[42:43], v8 offset:31616
  s_add_u32 m0, s30, 3072
  s_nop 0
  buffer_load_dwordx4 v16, s[12:15], s33 offen lds
  s_waitcnt lgkmcnt(2)
  v_mfma_f32_32x32x16_bf16 v[72:87], v[36:39], v[24:27], v[72:87]
  ds_read_b128 v[28:31], v7 offset:8192
  ds_read_b64_tr_b16 v[48:49], v8 offset:33856
  ds_read_b64_tr_b16 v[50:51], v8 offset:34624
  s_mul_i32 s32, s46, 196608
  s_add_u32 s32, s32, s29
  s_add_u32 m0, s31, 49152
  s_nop 0
  buffer_load_dwordx4 v10, s[16:19], s32 offen lds
  s_waitcnt lgkmcnt(3)
  v_mfma_f32_32x32x16_bf16 v[88:103], v[24:27], v[40:43], v[88:103]
  ds_read_b64_tr_b16 v[52:53], v8 offset:33920
  ds_read_b64_tr_b16 v[54:55], v8 offset:34688
  s_add_u32 m0, s31, 50176
  s_nop 0
  buffer_load_dwordx4 v11, s[16:19], s32 offen lds
  s_waitcnt lgkmcnt(2)
  v_mfma_f32_32x32x16_bf16 v[72:87], v[48:51], v[28:31], v[72:87]
  s_add_u32 m0, s31, 51200
  s_nop 0
  buffer_load_dwordx4 v12, s[16:19], s32 offen lds
  s_waitcnt lgkmcnt(0)
  v_mfma_f32_32x32x16_bf16 v[88:103], v[28:31], v[52:55], v[88:103]
  s_waitcnt vmcnt(7)
  s_barrier
  ds_read_b128 v[24:27], v4 offset:12288
  ds_read_b64_tr_b16 v[36:37], v8 offset:36928
  ds_read_b64_tr_b16 v[38:39], v8 offset:37696
  ds_read_b64_tr_b16 v[40:41], v8 offset:36992
  ds_read_b64_tr_b16 v[42:43], v8 offset:37760
  s_waitcnt lgkmcnt(2)
  v_mfma_f32_32x32x16_bf16 v[72:87], v[36:39], v[24:27], v[72:87]
  ds_read_b128 v[28:31], v5 offset:12288
  ds_read_b64_tr_b16 v[48:49], v8 offset:40000
  ds_read_b64_tr_b16 v[50:51], v8 offset:40768
  s_add_u32 s46, s45, 5
  s_and_b32 s46, s46, 7
  s_lshl_b32 s33, s46, 7
  s_add_u32 s33, s33, s28
  s_add_u32 m0, s30, 4096
  s_nop 0
  buffer_load_dwordx4 v13, s[12:15], s33 offen lds
  s_waitcnt lgkmcnt(3)
  v_mfma_f32_32x32x16_bf16 v[88:103], v[24:27], v[40:43], v[88:103]
  ds_read_b64_tr_b16 v[52:53], v8 offset:40064
  ds_read_b64_tr_b16 v[54:55], v8 offset:40832
  s_add_u32 m0, s30, 5120
  s_nop 0
  buffer_load_dwordx4 v14, s[12:15], s33 offen lds
  s_waitcnt lgkmcnt(2)
  v_mfma_f32_32x32x16_bf16 v[72:87], v[48:51], v[28:31], v[72:87]
  ds_read_b128 v[24:27], v6 offset:12288
  ds_read_b64_tr_b16 v[36:37], v8 offset:43072
  ds_read_b64_tr_b16 v[38:39], v8 offset:43840
  s_add_u32 m0, s30, 6144
  s_nop 0
  buffer_load_dwordx4 v15, s[12:15], s33 offen lds
  s_waitcnt lgkmcnt(3)
  v_mfma_f32_32x32x16_bf16 v[88:103], v[28:31], v[52:55], v[88:103]
  ds_read_b64_tr_b16 v[40:41], v8 offset:43136
  ds_read_b64_tr_b16 v[42:43], v8 offset:43904
  s_add_u32 m0, s30, 7168
  s_nop 0
  buffer_load_dwordx4 v16, s[12:15], s33 offen lds
  s_waitcnt lgkmcnt(2)
  v_mfma_f32_32x32x16_bf16 v[72:87], v[36:39], v[24:27], v[72:87]
  ds_read_b128 v[28:31], v7 offset:12288
  ds_read_b64_tr_b16 v[48:49], v8 offset:46144
  ds_read_b64_tr_b16 v[50:51], v8 offset:46912
  s_mul_i32 s32, s46, 196608
  s_add_u32 s32, s32, s29
  s_add_u32 m0, s31, 61440
  s_nop 0
  buffer_load_dwordx4 v10, s[16:19], s32 offen lds
  s_waitcnt lgkmcnt(3)
  v_mfma_f32_32x32x16_bf16 v[88:103], v[24:27], v[40:43], v[88:103]
  ds_read_b64_tr_b16 v[52:53], v8 offset:46208
  ds_read_b64_tr_b16 v[54:55], v8 offset:46976
  s_add_u32 m0, s31, 62464
  s_nop 0
  buffer_load_dwordx4 v11, s[16:19], s32 offen lds
  s_waitcnt lgkmcnt(2)
  v_mfma_f32_32x32x16_bf16 v[72:87], v[48:51], v[28:31], v[72:87]
  s_add_u32 m0, s31, 63488
  s_nop 0
  buffer_load_dwordx4 v12, s[16:19], s32 offen lds
  s_waitcnt lgkmcnt(0)
  v_mfma_f32_32x32x16_bf16 v[88:103], v[28:31], v[52:55], v[88:103]
  s_waitcnt vmcnt(7)
  s_barrier
  ds_read_b128 v[24:27], v4 offset:0
  ds_read_b64_tr_b16 v[36:37], v9 offset:64
  ds_read_b64_tr_b16 v[38:39], v9 offset:832
  ds_read_b64_tr_b16 v[40:41], v9 offset:128
  ds_read_b64_tr_b16 v[42:43], v9 offset:896
  s_waitcnt lgkmcnt(2)
  v_mfma_f32_32x32x16_bf16 v[72:87], v[36:39], v[24:27], v[72:87]
  ds_read_b128 v[28:31], v5 offset:0
  ds_read_b64_tr_b16 v[48:49], v9 offset:3136
  ds_read_b64_tr_b16 v[50:51], v9 offset:3904
  s_add_u32 s46, s45, 6
  s_and_b32 s46, s46, 7
  s_lshl_b32 s33, s46, 7
  s_add_u32 s33, s33, s28
  s_add_u32 m0, s30, 8192
  s_nop 0
  buffer_load_dwordx4 v13, s[12:15], s33 offen lds
  s_waitcnt lgkmcnt(3)
  v_mfma_f32_32x32x16_bf16 v[88:103], v[24:27], v[40:43], v[88:103]
  ds_read_b64_tr_b16 v[52:53], v9 offset:3200
  ds_read_b64_tr_b16 v[54:55], v9 offset:3968
  s_add_u32 m0, s30, 9216
  s_nop 0
  buffer_load_dwordx4 v14, s[12:15], s33 offen lds
  s_waitcnt lgkmcnt(2)
  v_mfma_f32_32x32x16_bf16 v[72:87], v[48:51], v[28:31], v[72:87]
  ds_read_b128 v[24:27], v6 offset:0
  ds_read_b64_tr_b16 v[36:37], v9 offset:6208
  ds_read_b64_tr_b16 v[38:39], v9 offset:6976
  s_add_u32 m0, s30, 10240
  s_nop 0
  buffer_load_dwordx4 v15, s[12:15], s33 offen lds
  s_waitcnt lgkmcnt(3)
  v_mfma_f32_32x32x16_bf16 v[88:103], v[28:31], v[52:55], v[88:103]
  ds_read_b64_tr_b16 v[40:41], v9 offset:6272
  ds_read_b64_tr_b16 v[42:43], v9 offset:7040
  s_add_u32 m0, s30, 11264
  s_nop 0
  buffer_load_dwordx4 v16, s[12:15], s33 offen lds
  s_waitcnt lgkmcnt(2)
  v_mfma_f32_32x32x16_bf16 v[72:87], v[36:39], v[24:27], v[72:87]
  ds_read_b128 v[28:31], v7 offset:0
  ds_read_b64_tr_b16 v[48:49], v9 offset:9280
  ds_read_b64_tr_b16 v[50:51], v9 offset:10048
  s_mul_i32 s32, s46, 196608
  s_add_u32 s32, s32, s29
  s_add_u32 m0, s31, 73728
  s_nop 0
  buffer_load_dwordx4 v10, s[16:19], s32 offen lds
  s_waitcnt lgkmcnt(3)
  v_mfma_f32_32x32x16_bf16 v[88:103], v[24:27], v[40:43], v[88:103]
  ds_read_b64_tr_b16 v[52:53], v9 offset:9344
  ds_read_b64_tr_b16 v[54:55], v9 offset:10112
  s_add_u32 m0, s31, 74752
  s_nop 0
  buffer_load_dwordx4 v11, s[16:19], s32 offen lds
  s_waitcnt lgkmcnt(2)
  v_mfma_f32_32x32x16_bf16 v[72:87], v[48:51], v[28:31], v[72:87]
  s_add_u32 m0, s31, 75776
  s_nop 0
  buffer_load_dwordx4 v12, s[16:19], s32 offen lds
  s_waitcnt lgkmcnt(0)
  v_mfma_f32_32x32x16_bf16 v[88:103], v[28:31], v[52:55], v[88:103]
  s_waitcnt vmcnt(7)
  s_barrier
  ds_read_b128 v[24:27], v4 offset:4096
  ds_read_b64_tr_b16 v[36:37], v9 offset:12352
  ds_read_b64_tr_b16 v[38:39], v9 offset:13120
  ds_read_b64_tr_b16 v[40:41], v9 offset:12416
  ds_read_b64_tr_b16 v[42:43], v9 offset:13184
  s_waitcnt lgkmcnt(2)
  v_mfma_f32_32x32x16_bf16 v[72:87], v[36:39], v[24:27], v[72:87]
  ds_read_b128 v[28:31], v5 offset:4096
  ds_read_b64_tr_b16 v[48:49], v9 offset:15424
  ds_read_b64_tr_b16 v[50:51], v9 offset:16192
  s_add_u32 s46, s45, 7
  s_and_b32 s46, s46, 7
  s_lshl_b32 s33, s46, 7
  s_add_u32 s33, s33, s28
  s_add_u32 m0, s30, 12288
  s_nop 0
  buffer_load_dwordx4 v13, s[12:15], s33 offen lds
  s_waitcnt lgkmcnt(3)
  v_mfma_f32_32x32x16_bf16 v[88:103], v[24:27], v[40:43], v[88:103]
  ds_read_b64_tr_b16 v[52:53], v9 offset:15488
  ds_read_b64_tr_b16 v[54:55], v9 offset:16256
  s_add_u32 m0, s30, 13312
  s_nop 0
  buffer_load_dwordx4 v14, s[12:15], s33 offen lds
  s_waitcnt lgkmcnt(2)
  v_mfma_f32_32x32x16_bf16 v[72:87], v[48:51], v[28:31], v[72:87]
  ds_read_b128 v[24:27], v6 offset:4096
  ds_read_b64_tr_b16 v[36:37], v9 offset:18496
  ds_read_b64_tr_b16 v[38:39], v9 offset:19264
  s_add_u32 m0, s30, 14336
  s_nop 0
  buffer_load_dwordx4 v15, s[12:15], s33 offen lds
  s_waitcnt lgkmcnt(3)
  v_mfma_f32_32x32x16_bf16 v[88:103], v[28:31], v[52:55], v[88:103]
  ds_read_b64_tr_b16 v[40:41], v9 offset:18560
  ds_read_b64_tr_b16 v[42:43], v9 offset:19328
  s_add_u32 m0, s30, 15360
  s_nop 0
  buffer_load_dwordx4 v16, s[12:15], s33 offen lds
  s_waitcnt lgkmcnt(2)
  v_mfma_f32_32x32x16_bf16 v[72:87], v[36:39], v[24:27], v[72:87]
  ds_read_b128 v[28:31], v7 offset:4096
  ds_read_b64_tr_b16 v[48:49], v9 offset:21568
  ds_read_b64_tr_b16 v[50:51], v9 offset:22336
  s_mul_i32 s32, s46, 196608
  s_add_u32 s32, s32, s29
  s_add_u32 m0, s31, 86016
  s_nop 0
  buffer_load_dwordx4 v10, s[16:19], s32 offen lds
  s_waitcnt lgkmcnt(3)
  v_mfma_f32_32x32x16_bf16 v[88:103], v[24:27], v[40:43], v[88:103]
  ds_read_b64_tr_b16 v[52:53], v9 offset:21632
  ds_read_b64_tr_b16 v[54:55], v9 offset:22400
  s_add_u32 m0, s31, 87040
  s_nop 0
  buffer_load_dwordx4 v11, s[16:19], s32 offen lds
  s_waitcnt lgkmcnt(2)
  v_mfma_f32_32x32x16_bf16 v[72:87], v[48:51], v[28:31], v[72:87]
  s_add_u32 m0, s31, 88064
  s_nop 0
  buffer_load_dwordx4 v12, s[16:19], s32 offen lds
  s_waitcnt lgkmcnt(0)
  v_mfma_f32_32x32x16_bf16 v[88:103], v[28:31], v[52:55], v[88:103]
  s_waitcnt vmcnt(7)
  s_barrier
  ds_read_b128 v[24:27], v4 offset:8192
  ds_read_b64_tr_b16 v[36:37], v9 offset:24640
  ds_read_b64_tr_b16 v[38:39], v9 offset:25408
  ds_read_b64_tr_b16 v[40:41], v9 offset:24704
  ds_read_b64_tr_b16 v[42:43], v9 offset:25472
  s_waitcnt lgkmcnt(2)
  v_mfma_f32_32x32x16_bf16 v[72:87], v[36:39], v[24:27], v[72:87]
  ds_read_b128 v[28:31], v5 offset:8192
  ds_read_b64_tr_b16 v[48:49], v9 offset:27712
  ds_read_b64_tr_b16 v[50:51], v9 offset:28480
  s_waitcnt lgkmcnt(3)
  v_mfma_f32_32x32x16_bf16 v[88:103], v[24:27], v[40:43], v[88:103]
  ds_read_b64_tr_b16 v[52:53], v9 offset:27776
  ds_read_b64_tr_b16 v[54:55], v9 offset:28544
  s_waitcnt lgkmcnt(2)
  v_mfma_f32_32x32x16_bf16 v[72:87], v[48:51], v[28:31], v[72:87]
  ds_read_b128 v[24:27], v6 offset:8192
  ds_read_b64_tr_b16 v[36:37], v9 offset:30784
  ds_read_b64_tr_b16 v[38:39], v9 offset:31552
  s_waitcnt lgkmcnt(3)
  v_mfma_f32_32x32x16_bf16 v[88:103], v[28:31], v[52:55], v[88:103]
  ds_read_b64_tr_b16 v[40:41], v9 offset:30848
  ds_read_b64_tr_b16 v[42:43], v9 offset:31616
  s_waitcnt lgkmcnt(2)
  v_mfma_f32_32x32x16_bf16 v[72:87], v[36:39], v[24:27], v[72:87]
  ds_read_b128 v[28:31], v7 offset:8192
  ds_read_b64_tr_b16 v[48:49], v9 offset:33856
  ds_read_b64_tr_b16 v[50:51], v9 offset:34624
  s_waitcnt lgkmcnt(3)
  v_mfma_f32_32x32x16_bf16 v[88:103], v[24:27], v[40:43], v[88:103]
  ds_read_b64_tr_b16 v[52:53], v9 offset:33920
  ds_read_b64_tr_b16 v[54:55], v9 offset:34688
  s_waitcnt lgkmcnt(2)
  v_mfma_f32_32x32x16_bf16 v[72:87], v[48:51], v[28:31], v[72:87]
  s_waitcnt lgkmcnt(0)
  v_mfma_f32_32x32x16_bf16 v[88:103], v[28:31], v[52:55], v[88:103]
  s_waitcnt vmcnt(0)
  s_barrier
  ds_read_b128 v[24:27], v4 offset:12288
  ds_read_b64_tr_b16 v[36:37], v9 offset:36928
  ds_read_b64_tr_b16 v[38:39], v9 offset:37696
  ds_read_b64_tr_b16 v[40:41], v9 offset:36992
  ds_read_b64_tr_b16 v[42:43], v9 offset:37760
  s_waitcnt lgkmcnt(2)
  v_mfma_f32_32x32x16_bf16 v[72:87], v[36:39], v[24:27], v[72:87]
  ds_read_b128 v[28:31], v5 offset:12288
  ds_read_b64_tr_b16 v[48:49], v9 offset:40000
  ds_read_b64_tr_b16 v[50:51], v9 offset:40768
  s_waitcnt lgkmcnt(3)
  v_mfma_f32_32x32x16_bf16 v[88:103], v[24:27], v[40:43], v[88:103]
  ds_read_b64_tr_b16 v[52:53], v9 offset:40064
  ds_read_b64_tr_b16 v[54:55], v9 offset:40832
  s_waitcnt lgkmcnt(2)
  v_mfma_f32_32x32x16_bf16 v[72:87], v[48:51], v[28:31], v[72:87]
  ds_read_b128 v[24:27], v6 offset:12288
  ds_read_b64_tr_b16 v[36:37], v9 offset:43072
  ds_read_b64_tr_b16 v[38:39], v9 offset:43840
  s_waitcnt lgkmcnt(3)
  v_mfma_f32_32x32x16_bf16 v[88:103], v[28:31], v[52:55], v[88:103]
  ds_read_b64_tr_b16 v[40:41], v9 offset:43136
  ds_read_b64_tr_b16 v[42:43], v9 offset:43904
  s_waitcnt lgkmcnt(2)
  v_mfma_f32_32x32x16_bf16 v[72:87], v[36:39], v[24:27], v[72:87]
  ds_read_b128 v[28:31], v7 offset:12288
  ds_read_b64_tr_b16 v[48:49], v9 offset:46144
  ds_read_b64_tr_b16 v[50:51], v9 offset:46912
  s_waitcnt lgkmcnt(3)
  v_mfma_f32_32x32x16_bf16 v[88:103], v[24:27], v[40:43], v[88:103]
  ds_read_b64_tr_b16 v[52:53], v9 offset:46208
  ds_read_b64_tr_b16 v[54:55], v9 offset:46976
  s_waitcnt lgkmcnt(2)
  v_mfma_f32_32x32x16_bf16 v[72:87], v[48:51], v[28:31], v[72:87]
  s_waitcnt lgkmcnt(0)
  v_mfma_f32_32x32x16_bf16 v[88:103], v[28:31], v[52:55], v[88:103]
  v_and_b32 v104, 31, v1
  v_lshrrev_b32 v105, 5, v1
  v_lshlrev_b32 v106, 4, v105
  v_add_u32 v106, 0, v106
  v_lshlrev_b32 v107, 2, v104
  v_add_u32 v107, 0, v107
  s_lshl_b32 s3, s43, 8
  v_add_u32 v2, s3, v107
  v_add_u32 v3, s3, v106
  s_lshl_b32 s3, s43, 11
  v_bfe_u32 v110, v1, 4, 1
  v_lshlrev_b32 v110, 13, v110
  v_lshl_add_u32 v110, v105, 8, v110
  v_and_b32 v111, 15, v1
  v_lshl_add_u32 v110, v111, 4, v110
  v_add_u32 v110, s3, v110
  v_lshlrev_b32 v111, 4, v1
  v_add_u32 v111, s3, v111
  s_lshl_b32 s46, s21, 14
  s_add_u32 s46, s46, s47
  s_add_u32 s48, s46, 8192
  s_barrier
  v_mov_b32 v8, 0
  ds_read_b32 v9, v8 offset:8384
  ds_read_b32 v108, v2 offset:512
  ds_read_b32 v109, v2 offset:640
  ds_read_b128 v[24:27], v106 offset:128
  ds_read_b128 v[28:31], v106 offset:160
  ds_read_b128 v[32:35], v106 offset:192
  ds_read_b128 v[36:39], v106 offset:224
  ds_read_b32 v40, v107 offset:256
  ds_read_b128 v[112:115], v3 offset:512
  ds_read_b128 v[128:131], v3 offset:640
  ds_read_b128 v[116:119], v3 offset:544
  ds_read_b128 v[132:135], v3 offset:672
  ds_read_b128 v[120:123], v3 offset:576
  ds_read_b128 v[136:139], v3 offset:704
  ds_read_b128 v[124:127], v3 offset:608
  ds_read_b128 v[140:143], v3 offset:736
  s_lshl_b32 s37, s22, 9
  s_lshl_b32 s3, s23, 2
  s_add_u32 s37, s37, s3
  s_add_u32 s37, s37, 12648448
  s_waitcnt lgkmcnt(9)
  v_readfirstlane_b32 s55, v9
  v_fma_f32 v72, -v108, v24, v72
  v_fma_f32 v73, -v108, v25, v73
  v_fma_f32 v74, -v108, v26, v74
  v_fma_f32 v75, -v108, v27, v75
  v_fma_f32 v76, -v108, v28, v76
  v_fma_f32 v77, -v108, v29, v77
  v_fma_f32 v78, -v108, v30, v78
  v_fma_f32 v79, -v108, v31, v79
  v_fma_f32 v80, -v108, v32, v80
  v_fma_f32 v81, -v108, v33, v81
  v_fma_f32 v82, -v108, v34, v82
  v_fma_f32 v83, -v108, v35, v83
  v_fma_f32 v84, -v108, v36, v84
  v_fma_f32 v85, -v108, v37, v85
  v_fma_f32 v86, -v108, v38, v86
  v_fma_f32 v87, -v108, v39, v87
  v_mul_f32 v72, v109, v72
  v_mul_f32 v73, v109, v73
  v_mul_f32 v74, v109, v74
  v_mul_f32 v75, v109, v75
  v_mul_f32 v76, v109, v76
  v_mul_f32 v77, v109, v77
  v_mul_f32 v78, v109, v78
  v_mul_f32 v79, v109, v79
  v_mul_f32 v80, v109, v80
  v_mul_f32 v81, v109, v81
  v_mul_f32 v82, v109, v82
  v_mul_f32 v83, v109, v83
  v_mul_f32 v84, v109, v84
  v_mul_f32 v85, v109, v85
  v_mul_f32 v86, v109, v86
  v_mul_f32 v87, v109, v87
  v_cvt_pk_bf16_f32 v72, v72, v73
  v_cvt_pk_bf16_f32 v73, v74, v75
  v_cvt_pk_bf16_f32 v74, v76, v77
  v_cvt_pk_bf16_f32 v75, v78, v79
  v_cvt_pk_bf16_f32 v76, v80, v81
  v_cvt_pk_bf16_f32 v77, v82, v83
  v_cvt_pk_bf16_f32 v78, v84, v85
  v_cvt_pk_bf16_f32 v79, v86, v87
  s_cmp_eq_u32 s55, 1
  s_cbranch_scc0 K_sl_1
  buffer_store_dwordx4 v[72:75], v111, s[24:27], s46 offen
  buffer_store_dwordx4 v[76:79], v111, s[24:27], s48 offen
  s_branch K_sj_2
K_sl_1:
  buffer_store_dwordx4 v[72:75], v111, s[24:27], s46 offen sc1
  buffer_store_dwordx4 v[76:79], v111, s[24:27], s48 offen sc1
K_sj_2:
  s_waitcnt lgkmcnt(0)
  v_fma_f32 v88, -v112, v40, v88
  v_fma_f32 v89, -v113, v40, v89
  v_fma_f32 v90, -v114, v40, v90
  v_fma_f32 v91, -v115, v40, v91
  v_fma_f32 v92, -v116, v40, v92
  v_fma_f32 v93, -v117, v40, v93
  v_fma_f32 v94, -v118, v40, v94
  v_fma_f32 v95, -v119, v40, v95
  v_fma_f32 v96, -v120, v40, v96
  v_fma_f32 v97, -v121, v40, v97
  v_fma_f32 v98, -v122, v40, v98
  v_fma_f32 v99, -v123, v40, v99
  v_fma_f32 v100, -v124, v40, v100
  v_fma_f32 v101, -v125, v40, v101
  v_fma_f32 v102, -v126, v40, v102
  v_fma_f32 v103, -v127, v40, v103
  v_mul_f32 v88, v128, v88
  v_mul_f32 v89, v129, v89
  v_mul_f32 v90, v130, v90
  v_mul_f32 v91, v131, v91
  v_mul_f32 v92, v132, v92
  v_mul_f32 v93, v133, v93
  v_mul_f32 v94, v134, v94
  v_mul_f32 v95, v135, v95
  v_mul_f32 v96, v136, v96
  v_mul_f32 v97, v137, v97
  v_mul_f32 v98, v138, v98
  v_mul_f32 v99, v139, v99
  v_mul_f32 v100, v140, v100
  v_mul_f32 v101, v141, v101
  v_mul_f32 v102, v142, v102
  v_mul_f32 v103, v143, v103
  v_cvt_pk_bf16_f32 v88, v88, v89
  v_cvt_pk_bf16_f32 v89, v90, v91
  v_cvt_pk_bf16_f32 v90, v92, v93
  v_cvt_pk_bf16_f32 v91, v94, v95
  v_cvt_pk_bf16_f32 v92, v96, v97
  v_cvt_pk_bf16_f32 v93, v98, v99
  v_cvt_pk_bf16_f32 v94, v100, v101
  v_cvt_pk_bf16_f32 v95, v102, v103
  s_cmp_eq_u32 s55, 1
  s_cbranch_scc0 K_sl_3
  buffer_store_dwordx4 v[88:91], v110, s[24:27], s46 offen offset:1024
  buffer_store_dwordx4 v[92:95], v110, s[24:27], s46 offen offset:1536
  s_branch K_sj_4
K_sl_3:
  buffer_store_dwordx4 v[88:91], v110, s[24:27], s46 offen offset:1024 sc1
  buffer_store_dwordx4 v[92:95], v110, s[24:27], s46 offen offset:1536 sc1
K_sj_4:
  ds_write_b128 v111, v[72:75] offset:16384
  ds_write_b128 v111, v[76:79] offset:24576
  ds_write_b128 v110, v[88:91] offset:17408
  ds_write_b128 v110, v[92:95] offset:17920
  v_lshlrev_b32 v2, 4, v1
  s_lshl_b32 s3, s43, 10
  s_add_u32 s3, s3, 4096
  v_add_u32 v2, s3, v2
  v_mov_b32 v106, 0
  v_mov_b32 v107, 1
  s_mov_b32 s60, 0
  s_mov_b32 s38, 20
K_pubt:
  s_getreg_b32 s3, hwreg(HW_REG_IB_STS)
  s_and_b32 s3, s3, 0x00c0000f
  s_cbranch_scc0 K_pubnow
  s_sub_u32 s38, s38, 1
  s_cmp_lg_u32 s38, 0
  s_cbranch_scc1 K_pubt
  s_branch K_publ
K_pubnow:
  s_waitcnt vmcnt(0)
  s_mov_b64 exec, 1
  s_cmp_eq_u32 s55, 1
  s_cbranch_scc0 K_sl_5
  buffer_store_dword v107, v106, s[24:27], s37 offen
  s_branch K_sj_6
K_sl_5:
  buffer_store_dword v107, v106, s[24:27], s37 offen sc1
K_sj_6:
  s_mov_b64 exec, -1
  s_mov_b32 s60, 1
K_publ:
  s_waitcnt lgkmcnt(0)
  s_barrier
  ds_read_b128 v[96:99], v2
K_attn:
  v_mov_b32 v116, v1
  s_lshr_b32 s34, s20, 2
  s_lshl_b32 s35, s34, 13
  v_lshlrev_b32 v121, 4, v116
  v_add_u32 v121, s35, v121
  v_lshrrev_b32 v119, 5, v116
  v_and_b32 v120, 15, v116
  v_lshlrev_b32 v120, 4, v120
  v_lshl_add_u32 v122, v119, 8, v120
  v_add_u32 v122, s35, v122
  v_add_u32 v117, 16384, v121
  v_add_u32 v118, 16384, v122
  ds_read_b128 v[88:91], v117
  v_and_b32 v119, 27, v116
  v_cmp_eq_u32 vcc, 16, v119
  v_mov_b32 v120, 0x3f803f80
  v_mov_b32 v127, 1
  v_mov_b32 v125, 8452
  s_lshl_b32 s3, s20, 2
  s_add_u32 s3, s3, 8576
  v_mov_b32 v126, s3
  v_cndmask_b32 v100, 0, v120, vcc
  v_cndmask_b32 v101, 0, v120, vcc
  v_cndmask_b32 v102, 0, v120, vcc
  v_cndmask_b32 v103, 0, v120, vcc
  v_cndmask_b32 v104, 0, v120, vcc
  v_cndmask_b32 v105, 0, v120, vcc
  v_cndmask_b32 v106, 0, v120, vcc
  v_cndmask_b32 v107, 0, v120, vcc
  v_cndmask_b32 v108, 0, v120, vcc
  v_cndmask_b32 v109, 0, v120, vcc
  v_cndmask_b32 v110, 0, v120, vcc
  v_cndmask_b32 v111, 0, v120, vcc
  v_cndmask_b32 v112, 0, v120, vcc
  v_cndmask_b32 v113, 0, v120, vcc
  v_cndmask_b32 v114, 0, v120, vcc
  v_cndmask_b32 v115, 0, v120, vcc
  s_mov_b32 s40, 0x0000ffff
  s_mov_b32 s41, 0x0000ffff
  s_waitcnt lgkmcnt(0)
  v_mfma_f32_32x32x16_bf16 v[0:15], v[88:91], v[96:99], 0
  v_mov_b32 v32, 0
  v_mov_b32 v33, 0
  v_mov_b32 v34, 0
  v_mov_b32 v35, 0
  v_mov_b32 v36, 0
  v_mov_b32 v37, 0
  v_mov_b32 v38, 0
  v_mov_b32 v39, 0
  v_mov_b32 v40, 0
  v_mov_b32 v41, 0
  v_mov_b32 v42, 0
  v_mov_b32 v43, 0
  v_mov_b32 v44, 0
  v_mov_b32 v45, 0
  v_mov_b32 v46, 0
  v_mov_b32 v47, 0
  v_mov_b32 v84, 0
  v_mov_b32 v85, 0
  v_mov_b32 v86, 0
  v_mov_b32 v87, 0
  v_max3_f32 v119, v0, v1, v2
  v_max_f32 v119, v119, v3
  v_max3_f32 v119, v119, v4, v5
  v_max3_f32 v119, v119, v6, v7
  v_max3_f32 v119, v119, v8, v9
  v_max3_f32 v119, v119, v10, v11
  v_max3_f32 v119, v119, v12, v13
  v_max3_f32 v119, v119, v14, v15
  v_mov_b32 v120, v119
  s_nop 1
  v_permlane32_swap_b32 v119, v120
  s_nop 1
  v_max_f32 v119, v119, v120
  v_sub_f32 v48, 0, v119
  v_sub_f32 v49, 0, v119
  v_sub_f32 v50, 0, v119
  v_sub_f32 v51, 0, v119
  v_sub_f32 v52, 0, v119
  v_sub_f32 v53, 0, v119
  v_sub_f32 v54, 0, v119
  v_sub_f32 v55, 0, v119
  v_sub_f32 v56, 0, v119
  v_sub_f32 v57, 0, v119
  v_sub_f32 v58, 0, v119
  v_sub_f32 v59, 0, v119
  v_sub_f32 v60, 0, v119
  v_sub_f32 v61, 0, v119
  v_sub_f32 v62, 0, v119
  v_sub_f32 v63, 0, v119
  v_add_f32 v0, v0, v48
  v_add_f32 v1, v1, v48
  v_add_f32 v2, v2, v48
  v_add_f32 v3, v3, v48
  v_add_f32 v4, v4, v48
  v_add_f32 v5, v5, v48
  v_add_f32 v6, v6, v48
  v_add_f32 v7, v7, v48
  v_add_f32 v8, v8, v48
  v_add_f32 v9, v9, v48
  v_add_f32 v10, v10, v48
  v_add_f32 v11, v11, v48
  v_add_f32 v12, v12, v48
  v_add_f32 v13, v13, v48
  v_add_f32 v14, v14, v48
  v_add_f32 v15, v15, v48
  s_cmp_lg_u32 s60, 0
  s_cbranch_scc1 K_pub2
  v_mov_b32 v120, 0
  s_waitcnt vmcnt(0)
  s_mov_b64 exec, 1
  s_cmp_eq_u32 s55, 1
  s_cbranch_scc0 K_sl_7
  buffer_store_dword v127, v120, s[24:27], s37 offen
  s_branch K_sj_8
K_sl_7:
  buffer_store_dword v127, v120, s[24:27], s37 offen sc1
K_sj_8:
  s_mov_b64 exec, -1
K_pub2:
  s_mov_b32 s31, 0
  s_mov_b32 s36, 32768
  v_add_u32 v123, s36, v121
  s_setprio 2
.p2align 6
K_loop:
  ds_read_b128 v[92:95], v117 offset:2048
  s_mov_b64 exec, s[40:41]
  ds_read_b128 v[100:103], v118 offset:1024
  ds_read_b128 v[108:111], v118 offset:1536
  s_mov_b64 exec, -1
  v_exp_f32 v64, v0
  v_exp_f32 v65, v1
  v_exp_f32 v66, v2
  v_mfma_f32_32x32x16_bf16 v[32:47], v[112:115], v[84:87], v[32:47]
  v_exp_f32 v67, v3
  v_exp_f32 v68, v4
  v_exp_f32 v69, v5
  v_exp_f32 v70, v6
  v_exp_f32 v71, v7
  v_exp_f32 v72, v8
  s_waitcnt lgkmcnt(0)
  v_mfma_f32_32x32x16_bf16 v[16:31], v[92:95], v[96:99], v[48:63]
  v_cvt_pk_bf16_f32 v80, v64, v65
  v_cvt_pk_bf16_f32 v81, v66, v67
  v_cvt_pk_bf16_f32 v82, v68, v69
  v_cvt_pk_bf16_f32 v83, v70, v71
  v_exp_f32 v73, v9
  v_exp_f32 v74, v10
  v_mfma_f32_32x32x16_bf16 v[32:47], v[100:103], v[80:83], v[32:47]
  v_exp_f32 v75, v11
  v_exp_f32 v76, v12
  v_exp_f32 v77, v13
  v_exp_f32 v78, v14
  v_exp_f32 v79, v15
  v_cvt_pk_bf16_f32 v84, v72, v73
  v_cvt_pk_bf16_f32 v85, v74, v75
  v_cvt_pk_bf16_f32 v86, v76, v77
  v_cvt_pk_bf16_f32 v87, v78, v79
  ds_read_b128 v[88:91], v117 offset:4096
  s_mov_b64 exec, s[40:41]
  ds_read_b128 v[104:107], v118 offset:3072
  ds_read_b128 v[112:115], v118 offset:3584
  s_mov_b64 exec, -1
  v_exp_f32 v64, v16
  v_exp_f32 v65, v17
  v_exp_f32 v66, v18
  v_mfma_f32_32x32x16_bf16 v[32:47], v[108:111], v[84:87], v[32:47]
  v_exp_f32 v67, v19
  v_exp_f32 v68, v20
  v_exp_f32 v69, v21
  v_exp_f32 v70, v22
  v_exp_f32 v71, v23
  v_exp_f32 v72, v24
  s_waitcnt lgkmcnt(0)
  v_mfma_f32_32x32x16_bf16 v[0:15], v[88:91], v[96:99], v[48:63]
  v_cvt_pk_bf16_f32 v80, v64, v65
  v_cvt_pk_bf16_f32 v81, v66, v67
  v_cvt_pk_bf16_f32 v82, v68, v69
  v_cvt_pk_bf16_f32 v83, v70, v71
  v_exp_f32 v73, v25
  v_exp_f32 v74, v26
  v_mfma_f32_32x32x16_bf16 v[32:47], v[104:107], v[80:83], v[32:47]
  v_exp_f32 v75, v27
  v_exp_f32 v76, v28
  v_exp_f32 v77, v29
  v_exp_f32 v78, v30
  v_exp_f32 v79, v31
  v_cvt_pk_bf16_f32 v84, v72, v73
  v_cvt_pk_bf16_f32 v85, v74, v75
  v_cvt_pk_bf16_f32 v86, v76, v77
  v_cvt_pk_bf16_f32 v87, v78, v79
  ds_read_b128 v[92:95], v117 offset:6144
  s_mov_b64 exec, s[40:41]
  ds_read_b128 v[100:103], v118 offset:5120
  ds_read_b128 v[108:111], v118 offset:5632
  s_mov_b64 exec, -1
  ds_read_b32 v124, v125
  v_exp_f32 v64, v0
  v_exp_f32 v65, v1
  v_exp_f32 v66, v2
  v_mfma_f32_32x32x16_bf16 v[32:47], v[112:115], v[84:87], v[32:47]
  v_exp_f32 v67, v3
  v_exp_f32 v68, v4
  v_exp_f32 v69, v5
  v_exp_f32 v70, v6
  v_exp_f32 v71, v7
  v_exp_f32 v72, v8
  s_waitcnt lgkmcnt(0)
  v_mfma_f32_32x32x16_bf16 v[16:31], v[92:95], v[96:99], v[48:63]
  v_cvt_pk_bf16_f32 v80, v64, v65
  v_cvt_pk_bf16_f32 v81, v66, v67
  v_cvt_pk_bf16_f32 v82, v68, v69
  v_cvt_pk_bf16_f32 v83, v70, v71
  v_exp_f32 v73, v9
  v_exp_f32 v74, v10
  v_mfma_f32_32x32x16_bf16 v[32:47], v[100:103], v[80:83], v[32:47]
  v_exp_f32 v75, v11
  v_exp_f32 v76, v12
  v_exp_f32 v77, v13
  v_exp_f32 v78, v14
  v_exp_f32 v79, v15
  v_cvt_pk_bf16_f32 v84, v72, v73
  v_cvt_pk_bf16_f32 v85, v74, v75
  v_cvt_pk_bf16_f32 v86, v76, v77
  v_cvt_pk_bf16_f32 v87, v78, v79
  v_cmp_ne_u32 vcc, 0, v124
  s_cbranch_vccz K_wait
K_ready:
  ds_read_b128 v[88:91], v123
  s_mov_b64 exec, s[40:41]
  ds_read_b128 v[104:107], v118 offset:7168
  ds_read_b128 v[112:115], v118 offset:7680
  s_mov_b64 exec, -1
  v_exp_f32 v64, v16
  v_exp_f32 v65, v17
  v_exp_f32 v66, v18
  v_mfma_f32_32x32x16_bf16 v[32:47], v[108:111], v[84:87], v[32:47]
  v_exp_f32 v67, v19
  v_exp_f32 v68, v20
  v_exp_f32 v69, v21
  v_exp_f32 v70, v22
  v_exp_f32 v71, v23
  v_exp_f32 v72, v24
  s_waitcnt lgkmcnt(0)
  v_mfma_f32_32x32x16_bf16 v[0:15], v[88:91], v[96:99], v[48:63]
  ds_write_b32 v126, v127
  v_cvt_pk_bf16_f32 v80, v64, v65
  v_cvt_pk_bf16_f32 v81, v66, v67
  v_cvt_pk_bf16_f32 v82, v68, v69
  v_cvt_pk_bf16_f32 v83, v70, v71
  v_exp_f32 v73, v25
  v_exp_f32 v74, v26
  v_mfma_f32_32x32x16_bf16 v[32:47], v[104:107], v[80:83], v[32:47]
  v_exp_f32 v75, v27
  v_exp_f32 v76, v28
  v_exp_f32 v77, v29
  v_exp_f32 v78, v30
  v_exp_f32 v79, v31
  v_cvt_pk_bf16_f32 v84, v72, v73
  v_cvt_pk_bf16_f32 v85, v74, v75
  v_cvt_pk_bf16_f32 v86, v76, v77
  v_cvt_pk_bf16_f32 v87, v78, v79
  v_mov_b32 v117, v123
  v_add_u32 v118, s36, v122
  s_add_u32 s36, s36, 16384
  s_cmp_eq_u32 s36, 163840
  s_cselect_b32 s36, 16384, s36
  v_add_u32 v123, s36, v121
  v_add_u32 v125, 4, v125
  v_add_u32 v126, 32, v126
  s_add_u32 s31, s31, 1
  s_and_b32 s3, s31, 3
  s_cmp_lg_u32 s3, 0
  s_cbranch_scc1 K_loop
  s_cmp_eq_u32 s31, 4
  s_cbranch_scc0 K_p8
  s_setprio 2
  s_branch K_loop
K_p8:
  s_cmp_eq_u32 s31, 8
  s_cbranch_scc0 K_p12
  s_setprio 1
  s_branch K_loop
K_p12:
  s_setprio 0
  s_cmp_lg_u32 s31, 16
  s_cbranch_scc1 K_loop
  v_mfma_f32_32x32x16_bf16 v[32:47], v[112:115], v[84:87], v[32:47]
  v_lshlrev_b32 v117, 4, v116
  s_lshl_b32 s28, s23, 5
  s_lshl_b32 s3, s22, 1
  s_add_u32 s28, s28, s3
  s_add_u32 s28, s28, s34
  s_lshl_b32 s28, s28, 10
  s_add_u32 s28, s28, 6291456
  v_mov_b32 v119, 0x4f800000
  s_nop 7
  v_cmp_le_f32 vcc, v40, v119
  s_cmp_eq_u64 vcc, exec
  s_cbranch_scc0 K_fallback
K_fin:
  v_rcp_f32 v119, v40
  s_nop 0
  v_mul_f32 v32, v119, v32
  v_mul_f32 v33, v119, v33
  v_mul_f32 v34, v119, v34
  v_mul_f32 v35, v119, v35
  v_mul_f32 v36, v119, v36
  v_mul_f32 v37, v119, v37
  v_mul_f32 v38, v119, v38
  v_mul_f32 v39, v119, v39
  v_cvt_pk_bf16_f32 v32, v32, v33
  v_cvt_pk_bf16_f32 v33, v34, v35
  v_cvt_pk_bf16_f32 v34, v36, v37
  v_cvt_pk_bf16_f32 v35, v38, v39
  v_min_u32 v32, 0xfffffffe, v32
  v_min_u32 v33, 0xfffffffe, v33
  v_min_u32 v34, 0xfffffffe, v34
  v_min_u32 v35, 0xfffffffe, v35
  buffer_store_dwordx4 v[32:35], v117, s[24:27], s28 offen sc1
  s_load_dwordx2 s[4:5], s[0:1], 0
  s_load_dwordx2 s[10:11], s[0:1], 32
  s_load_dwordx2 s[6:7], s[0:1], 64
  s_sub_u32 s28, s28, 6291456
  s_lshr_b32 s28, s28, 4
  s_add_u32 s28, s28, 13107200
  v_mov_b32 v119, 0
  s_mov_b32 s44, 0xffff0000
  s_and_b32 s21, s2, 7
  s_lshl_b32 s21, s21, 2
  s_bfe_u32 s3, s2, 0x20003
  s_add_u32 s21, s21, s3
  s_lshr_b32 s22, s2, 5
  s_mov_b64 exec, 1
  buffer_store_dword v127, v119, s[24:27], s28 offen sc1
  s_mov_b64 exec, -1
  v_mov_b32 v1, v116
  v_lshlrev_b32 v2, 4, v1
  s_cmp_ge_u32 s20, 4
  s_cbranch_scc1 K_ffnw
  s_lshr_b32 s34, s43, 1
  s_and_b32 s35, s43, 1
  v_lshrrev_b32 v8, 5, v1
  v_and_b32 v9, 31, v1
  v_lshlrev_b32 v10, 10, v9
  v_lshl_add_u32 v10, v8, 4, v10
  s_lshl_b32 s36, s21, 1
  s_add_u32 s36, s36, s34
  s_lshl_b32 s37, s36, 15
  s_lshl_b32 s47, s22, 1
  s_add_u32 s47, s47, s35
  s_lshl_b32 s39, s47, 6
  s_add_u32 s37, s37, s39
  v_lshlrev_b32 v6, 3, v8
  s_waitcnt lgkmcnt(0)
  s_mov_b32 s12, s4
  s_mov_b32 s13, s5
  s_mov_b32 s14, 2097152
  s_mov_b32 s15, 0x20000
  s_mov_b32 s28, s10
  s_mov_b32 s29, s11
  s_mov_b32 s30, 1024
  s_mov_b32 s31, 0x20000
  buffer_load_dwordx4 v[12:15], v10, s[12:15], s37 offen
  buffer_load_dwordx4 v[16:19], v10, s[12:15], s37 offen offset:32
  buffer_load_dwordx2 v[20:21], v6, s[28:31], s39 offen offset:0
  buffer_load_dwordx2 v[22:23], v6, s[28:31], s39 offen offset:16
  buffer_load_dwordx2 v[24:25], v6, s[28:31], s39 offen offset:32
  buffer_load_dwordx2 v[26:27], v6, s[28:31], s39 offen offset:48
  v_bfe_u32 v6, v1, 2, 2
  v_lshl_add_u32 v7, v8, 2, v6
  v_lshlrev_b32 v5, 7, v7
  v_bfe_u32 v6, v1, 3, 1
  v_lshlrev_b32 v6, 6, v6
  s_lshl_b32 s3, s35, 6
  v_xor_b32 v6, s3, v6
  v_add_u32 v5, v5, v6
  v_bfe_u32 v6, v1, 4, 1
  v_lshl_add_u32 v5, v6, 5, v5
  v_and_b32 v6, 3, v1
  v_lshl_add_u32 v5, v6, 3, v5
  v_add_u32 v5, 32768, v5
  v_mov_b32 v11, 0x3f803f80
  v_mov_b32 v44, 0
  v_mov_b32 v45, 0
  v_mov_b32 v46, 0
  v_mov_b32 v47, 0
  v_mov_b32 v48, 0
  v_mov_b32 v49, 0
  v_mov_b32 v50, 0
  v_mov_b32 v51, 0
  v_mov_b32 v52, 0
  v_mov_b32 v53, 0
  v_mov_b32 v54, 0
  v_mov_b32 v55, 0
  v_mov_b32 v56, 0
  v_mov_b32 v57, 0
  v_mov_b32 v58, 0
  v_mov_b32 v59, 0
  v_mov_b32 v3, 0
  v_and_b32 v0, 15, v1
  v_lshlrev_b32 v0, 7, v0
  s_lshl_b32 s45, s36, 11
  s_add_u32 s45, s45, 13107200
  s_lshl_b32 s46, s36, 15
  s_add_u32 s46, s46, 6291456
  s_mov_b32 s38, 1600000
K_wrdy:
  ds_read_b32 v6, v3 offset:9088
  s_waitcnt lgkmcnt(0)
  v_cmp_ne_u32 vcc, 0, v6
  s_cmp_eq_u64 vcc, exec
  s_cbranch_scc1 K_wrdy_ok
  s_sleep 2
  s_sub_u32 s38, s38, 1
  s_cmp_lg_u32 s38, 0
  s_cbranch_scc1 K_wrdy
K_wrdy_ok:
  s_mov_b32 s38, 200000
K_pfe:
  buffer_load_dword v6, v0, s[24:27], s45 offen sc1
  s_waitcnt vmcnt(0)
  v_cmp_ne_u32 vcc, 0, v6
  s_cmp_eq_u64 vcc, exec
  s_cbranch_scc1 K_pfe_ok
  s_sleep 3
  s_sub_u32 s38, s38, 1
  s_cmp_lg_u32 s38, 0
  s_cbranch_scc1 K_pfe
K_pfe_ok:
  s_mov_b32 s38, 200000
K_evr:
  s_add_u32 s3, s46, 0
  buffer_load_dwordx4 v[104:107], v2, s[24:27], s3 offen offset:0 sc1
  buffer_load_dwordx4 v[108:111], v2, s[24:27], s3 offen offset:2048 sc1
  s_add_u32 s3, s46, 4096
  buffer_load_dwordx4 v[112:115], v2, s[24:27], s3 offen offset:0 sc1
  buffer_load_dwordx4 v[116:119], v2, s[24:27], s3 offen offset:2048 sc1
  s_add_u32 s3, s46, 8192
  buffer_load_dwordx4 v[120:123], v2, s[24:27], s3 offen offset:0 sc1
  buffer_load_dwordx4 v[124:127], v2, s[24:27], s3 offen offset:2048 sc1
  s_add_u32 s3, s46, 12288
  buffer_load_dwordx4 v[128:131], v2, s[24:27], s3 offen offset:0 sc1
  buffer_load_dwordx4 v[132:135], v2, s[24:27], s3 offen offset:2048 sc1
  s_add_u32 s3, s46, 16384
  buffer_load_dwordx4 v[136:139], v2, s[24:27], s3 offen offset:0 sc1
  buffer_load_dwordx4 v[140:143], v2, s[24:27], s3 offen offset:2048 sc1
  s_add_u32 s3, s46, 20480
  buffer_load_dwordx4 v[144:147], v2, s[24:27], s3 offen offset:0 sc1
  buffer_load_dwordx4 v[148:151], v2, s[24:27], s3 offen offset:2048 sc1
  s_add_u32 s3, s46, 24576
  buffer_load_dwordx4 v[152:155], v2, s[24:27], s3 offen offset:0 sc1
  buffer_load_dwordx4 v[156:159], v2, s[24:27], s3 offen offset:2048 sc1
  s_add_u32 s3, s46, 28672
  buffer_load_dwordx4 v[160:163], v2, s[24:27], s3 offen offset:0 sc1
  buffer_load_dwordx4 v[164:167], v2, s[24:27], s3 offen offset:2048 sc1
  v_mov_b32 v7, 0
  ds_read_b64_tr_b16 v[28:29], v5 offset:0
  ds_read_b64_tr_b16 v[30:31], v5 offset:1024
  ds_read_b64_tr_b16 v[32:33], v5 offset:2048
  ds_read_b64_tr_b16 v[34:35], v5 offset:3072
  ds_read_b64_tr_b16 v[36:37], v5 offset:4096
  ds_read_b64_tr_b16 v[38:39], v5 offset:5120
  ds_read_b64_tr_b16 v[40:41], v5 offset:6144
  ds_read_b64_tr_b16 v[42:43], v5 offset:7168
  s_waitcnt vmcnt(15) lgkmcnt(6)
  v_mfma_f32_32x32x16_bf16 v[44:59], v[28:31], v[104:107], 0
  v_max3_u32 v7, v7, v104, v105
  v_max3_u32 v7, v7, v106, v107
  ds_read_b64_tr_b16 v[28:29], v5 offset:8192
  ds_read_b64_tr_b16 v[30:31], v5 offset:9216
  s_waitcnt vmcnt(14) lgkmcnt(6)
  v_mfma_f32_32x32x16_bf16 v[44:59], v[32:35], v[108:111], v[44:59]
  v_max3_u32 v7, v7, v108, v109
  v_max3_u32 v7, v7, v110, v111
  ds_read_b64_tr_b16 v[32:33], v5 offset:10240
  ds_read_b64_tr_b16 v[34:35], v5 offset:11264
  s_waitcnt vmcnt(13) lgkmcnt(6)
  v_mfma_f32_32x32x16_bf16 v[44:59], v[36:39], v[112:115], v[44:59]
  v_max3_u32 v7, v7, v112, v113
  v_max3_u32 v7, v7, v114, v115
  ds_read_b64_tr_b16 v[36:37], v5 offset:12288
  ds_read_b64_tr_b16 v[38:39], v5 offset:13312
  s_waitcnt vmcnt(12) lgkmcnt(6)
  v_mfma_f32_32x32x16_bf16 v[44:59], v[40:43], v[116:119], v[44:59]
  v_max3_u32 v7, v7, v116, v117
  v_max3_u32 v7, v7, v118, v119
  ds_read_b64_tr_b16 v[40:41], v5 offset:14336
  ds_read_b64_tr_b16 v[42:43], v5 offset:15360
  s_waitcnt vmcnt(11) lgkmcnt(6)
  v_mfma_f32_32x32x16_bf16 v[44:59], v[28:31], v[120:123], v[44:59]
  v_max3_u32 v7, v7, v120, v121
  v_max3_u32 v7, v7, v122, v123
  ds_read_b64_tr_b16 v[28:29], v5 offset:16384
  ds_read_b64_tr_b16 v[30:31], v5 offset:17408
  s_waitcnt vmcnt(10) lgkmcnt(6)
  v_mfma_f32_32x32x16_bf16 v[44:59], v[32:35], v[124:127], v[44:59]
  v_max3_u32 v7, v7, v124, v125
  v_max3_u32 v7, v7, v126, v127
  ds_read_b64_tr_b16 v[32:33], v5 offset:18432
  ds_read_b64_tr_b16 v[34:35], v5 offset:19456
  s_waitcnt vmcnt(9) lgkmcnt(6)
  v_mfma_f32_32x32x16_bf16 v[44:59], v[36:39], v[128:131], v[44:59]
  v_max3_u32 v7, v7, v128, v129
  v_max3_u32 v7, v7, v130, v131
  ds_read_b64_tr_b16 v[36:37], v5 offset:20480
  ds_read_b64_tr_b16 v[38:39], v5 offset:21504
  s_waitcnt vmcnt(8) lgkmcnt(6)
  v_mfma_f32_32x32x16_bf16 v[44:59], v[40:43], v[132:135], v[44:59]
  v_max3_u32 v7, v7, v132, v133
  v_max3_u32 v7, v7, v134, v135
  ds_read_b64_tr_b16 v[40:41], v5 offset:22528
  ds_read_b64_tr_b16 v[42:43], v5 offset:23552
  s_waitcnt vmcnt(7) lgkmcnt(6)
  v_mfma_f32_32x32x16_bf16 v[44:59], v[28:31], v[136:139], v[44:59]
  v_max3_u32 v7, v7, v136, v137
  v_max3_u32 v7, v7, v138, v139
  ds_read_b64_tr_b16 v[28:29], v5 offset:24576
  ds_read_b64_tr_b16 v[30:31], v5 offset:25600
  s_waitcnt vmcnt(6) lgkmcnt(6)
  v_mfma_f32_32x32x16_bf16 v[44:59], v[32:35], v[140:143], v[44:59]
  v_max3_u32 v7, v7, v140, v141
  v_max3_u32 v7, v7, v142, v143
  ds_read_b64_tr_b16 v[32:33], v5 offset:26624
  ds_read_b64_tr_b16 v[34:35], v5 offset:27648
  s_waitcnt vmcnt(5) lgkmcnt(6)
  v_mfma_f32_32x32x16_bf16 v[44:59], v[36:39], v[144:147], v[44:59]
  v_max3_u32 v7, v7, v144, v145
  v_max3_u32 v7, v7, v146, v147
  ds_read_b64_tr_b16 v[36:37], v5 offset:28672
  ds_read_b64_tr_b16 v[38:39], v5 offset:29696
  s_waitcnt vmcnt(4) lgkmcnt(6)
  v_mfma_f32_32x32x16_bf16 v[44:59], v[40:43], v[148:151], v[44:59]
  v_max3_u32 v7, v7, v148, v149
  v_max3_u32 v7, v7, v150, v151
  ds_read_b64_tr_b16 v[40:41], v5 offset:30720
  ds_read_b64_tr_b16 v[42:43], v5 offset:31744
  s_waitcnt vmcnt(3) lgkmcnt(6)
  v_mfma_f32_32x32x16_bf16 v[44:59], v[28:31], v[152:155], v[44:59]
  v_max3_u32 v7, v7, v152, v153
  v_max3_u32 v7, v7, v154, v155
  s_waitcnt vmcnt(2) lgkmcnt(4)
  v_mfma_f32_32x32x16_bf16 v[44:59], v[32:35], v[156:159], v[44:59]
  v_max3_u32 v7, v7, v156, v157
  v_max3_u32 v7, v7, v158, v159
  s_waitcnt vmcnt(1) lgkmcnt(2)
  v_mfma_f32_32x32x16_bf16 v[44:59], v[36:39], v[160:163], v[44:59]
  v_max3_u32 v7, v7, v160, v161
  v_max3_u32 v7, v7, v162, v163
  s_waitcnt vmcnt(0) lgkmcnt(0)
  v_mfma_f32_32x32x16_bf16 v[44:59], v[40:43], v[164:167], v[44:59]
  v_max3_u32 v7, v7, v164, v165
  v_max3_u32 v7, v7, v166, v167
  v_cmp_ne_u32 vcc, -1, v7
  s_cmp_eq_u64 vcc, exec
  s_cbranch_scc1 K_evok
  s_sub_u32 s38, s38, 1
  s_cmp_lg_u32 s38, 0
  s_cbranch_scc1 K_evr
K_evok:
  s_mov_b32 s38, 1600000
K_wrdy2:
  ds_read_b32 v6, v3 offset:9096
  s_waitcnt lgkmcnt(0)
  v_cmp_ne_u32 vcc, 0, v6
  s_cmp_eq_u64 vcc, exec
  s_cbranch_scc1 K_wrdy2_ok
  s_sleep 2
  s_sub_u32 s38, s38, 1
  s_cmp_lg_u32 s38, 0
  s_cbranch_scc1 K_wrdy2
K_wrdy2_ok:
  ds_read_b64_tr_b16 v[60:61], v5 offset:32768
  ds_read_b64_tr_b16 v[62:63], v5 offset:33792
  ds_read_b64_tr_b16 v[64:65], v5 offset:34816
  ds_read_b64_tr_b16 v[66:67], v5 offset:35840
  ds_read_b64_tr_b16 v[68:69], v5 offset:36864
  ds_read_b64_tr_b16 v[70:71], v5 offset:37888
  ds_read_b64_tr_b16 v[72:73], v5 offset:38912
  ds_read_b64_tr_b16 v[74:75], v5 offset:39936
  s_waitcnt lgkmcnt(4)
  ds_read_b64_tr_b16 v[76:77], v5 offset:40960
  ds_read_b64_tr_b16 v[78:79], v5 offset:41984
  ds_read_b64_tr_b16 v[80:81], v5 offset:43008
  ds_read_b64_tr_b16 v[82:83], v5 offset:44032
  ds_read_b64_tr_b16 v[84:85], v5 offset:45056
  ds_read_b64_tr_b16 v[86:87], v5 offset:46080
  v_and_b32 v7, 3, v1
  v_lshlrev_b32 v7, 2, v7
  s_mov_b32 s38, 1600000
K_opub:
  ds_read_b32 v6, v7 offset:9232
  s_waitcnt lgkmcnt(0)
  v_cmp_ne_u32 vcc, 0, v6
  s_cmp_eq_u64 vcc, exec
  s_cbranch_scc1 K_opub_ok
  s_sleep 2
  s_sub_u32 s38, s38, 1
  s_cmp_lg_u32 s38, 0
  s_cbranch_scc1 K_opub
K_opub_ok:
  s_mov_b32 s38, 200000
K_pfo:
  buffer_load_dword v6, v0, s[24:27], s45 offen offset:64 sc1
  s_waitcnt vmcnt(0)
  v_cmp_ne_u32 vcc, 0, v6
  s_cmp_eq_u64 vcc, exec
  s_cbranch_scc1 K_pfo_ok
  s_sleep 2
  s_sub_u32 s38, s38, 1
  s_cmp_lg_u32 s38, 0
  s_cbranch_scc1 K_pfo
K_pfo_ok:
  s_mov_b32 s38, 200000
K_oddr:
  s_add_u32 s3, s46, 0
  buffer_load_dwordx4 v[104:107], v2, s[24:27], s3 offen offset:1024 sc1
  buffer_load_dwordx4 v[108:111], v2, s[24:27], s3 offen offset:3072 sc1
  s_add_u32 s3, s46, 4096
  buffer_load_dwordx4 v[112:115], v2, s[24:27], s3 offen offset:1024 sc1
  buffer_load_dwordx4 v[116:119], v2, s[24:27], s3 offen offset:3072 sc1
  s_add_u32 s3, s46, 8192
  buffer_load_dwordx4 v[120:123], v2, s[24:27], s3 offen offset:1024 sc1
  buffer_load_dwordx4 v[124:127], v2, s[24:27], s3 offen offset:3072 sc1
  s_add_u32 s3, s46, 12288
  buffer_load_dwordx4 v[128:131], v2, s[24:27], s3 offen offset:1024 sc1
  buffer_load_dwordx4 v[132:135], v2, s[24:27], s3 offen offset:3072 sc1
  s_add_u32 s3, s46, 16384
  buffer_load_dwordx4 v[136:139], v2, s[24:27], s3 offen offset:1024 sc1
  buffer_load_dwordx4 v[140:143], v2, s[24:27], s3 offen offset:3072 sc1
  s_add_u32 s3, s46, 20480
  buffer_load_dwordx4 v[144:147], v2, s[24:27], s3 offen offset:1024 sc1
  buffer_load_dwordx4 v[148:151], v2, s[24:27], s3 offen offset:3072 sc1
  s_add_u32 s3, s46, 24576
  buffer_load_dwordx4 v[152:155], v2, s[24:27], s3 offen offset:1024 sc1
  buffer_load_dwordx4 v[156:159], v2, s[24:27], s3 offen offset:3072 sc1
  s_add_u32 s3, s46, 28672
  buffer_load_dwordx4 v[160:163], v2, s[24:27], s3 offen offset:1024 sc1
  buffer_load_dwordx4 v[164:167], v2, s[24:27], s3 offen offset:3072 sc1
  v_mov_b32 v7, 0
  ds_read_b64_tr_b16 v[28:29], v5 offset:47104
  ds_read_b64_tr_b16 v[30:31], v5 offset:48128
  ds_read_b64_tr_b16 v[32:33], v5 offset:49152
  ds_read_b64_tr_b16 v[34:35], v5 offset:50176
  ds_read_b64_tr_b16 v[36:37], v5 offset:51200
  ds_read_b64_tr_b16 v[38:39], v5 offset:52224
  s_waitcnt vmcnt(15) lgkmcnt(6)
  v_mfma_f32_32x32x16_bf16 v[88:103], v[60:63], v[104:107], v[44:59]
  v_max3_u32 v7, v7, v104, v105
  v_max3_u32 v7, v7, v106, v107
  s_waitcnt vmcnt(14) lgkmcnt(6)
  v_mfma_f32_32x32x16_bf16 v[88:103], v[64:67], v[108:111], v[88:103]
  v_max3_u32 v7, v7, v108, v109
  v_max3_u32 v7, v7, v110, v111
  s_waitcnt vmcnt(13) lgkmcnt(6)
  v_mfma_f32_32x32x16_bf16 v[88:103], v[68:71], v[112:115], v[88:103]
  v_max3_u32 v7, v7, v112, v113
  v_max3_u32 v7, v7, v114, v115
  s_waitcnt vmcnt(12) lgkmcnt(6)
  v_mfma_f32_32x32x16_bf16 v[88:103], v[72:75], v[116:119], v[88:103]
  v_max3_u32 v7, v7, v116, v117
  v_max3_u32 v7, v7, v118, v119
  s_waitcnt vmcnt(11) lgkmcnt(6)
  v_mfma_f32_32x32x16_bf16 v[88:103], v[76:79], v[120:123], v[88:103]
  v_max3_u32 v7, v7, v120, v121
  v_max3_u32 v7, v7, v122, v123
  s_waitcnt vmcnt(10) lgkmcnt(6)
  v_mfma_f32_32x32x16_bf16 v[88:103], v[80:83], v[124:127], v[88:103]
  v_max3_u32 v7, v7, v124, v125
  v_max3_u32 v7, v7, v126, v127
  s_waitcnt vmcnt(9) lgkmcnt(6)
  v_mfma_f32_32x32x16_bf16 v[88:103], v[84:87], v[128:131], v[88:103]
  v_max3_u32 v7, v7, v128, v129
  v_max3_u32 v7, v7, v130, v131
  ds_read_b64_tr_b16 v[40:41], v5 offset:53248
  ds_read_b64_tr_b16 v[42:43], v5 offset:54272
  s_waitcnt vmcnt(8) lgkmcnt(6)
  v_mfma_f32_32x32x16_bf16 v[88:103], v[28:31], v[132:135], v[88:103]
  v_max3_u32 v7, v7, v132, v133
  v_max3_u32 v7, v7, v134, v135
  ds_read_b64_tr_b16 v[28:29], v5 offset:55296
  ds_read_b64_tr_b16 v[30:31], v5 offset:56320
  s_waitcnt vmcnt(7) lgkmcnt(6)
  v_mfma_f32_32x32x16_bf16 v[88:103], v[32:35], v[136:139], v[88:103]
  v_max3_u32 v7, v7, v136, v137
  v_max3_u32 v7, v7, v138, v139
  ds_read_b64_tr_b16 v[32:33], v5 offset:57344
  ds_read_b64_tr_b16 v[34:35], v5 offset:58368
  s_waitcnt vmcnt(6) lgkmcnt(6)
  v_mfma_f32_32x32x16_bf16 v[88:103], v[36:39], v[140:143], v[88:103]
  v_max3_u32 v7, v7, v140, v141
  v_max3_u32 v7, v7, v142, v143
  ds_read_b64_tr_b16 v[36:37], v5 offset:59392
  ds_read_b64_tr_b16 v[38:39], v5 offset:60416
  s_waitcnt vmcnt(5) lgkmcnt(6)
  v_mfma_f32_32x32x16_bf16 v[88:103], v[40:43], v[144:147], v[88:103]
  v_max3_u32 v7, v7, v144, v145
  v_max3_u32 v7, v7, v146, v147
  ds_read_b64_tr_b16 v[40:41], v5 offset:61440
  ds_read_b64_tr_b16 v[42:43], v5 offset:62464
  s_waitcnt vmcnt(4) lgkmcnt(6)
  v_mfma_f32_32x32x16_bf16 v[88:103], v[28:31], v[148:151], v[88:103]
  v_max3_u32 v7, v7, v148, v149
  v_max3_u32 v7, v7, v150, v151
  ds_read_b64_tr_b16 v[28:29], v5 offset:63488
  ds_read_b64_tr_b16 v[30:31], v5 offset:64512
  s_waitcnt vmcnt(3) lgkmcnt(6)
  v_mfma_f32_32x32x16_bf16 v[88:103], v[32:35], v[152:155], v[88:103]
  v_max3_u32 v7, v7, v152, v153
  v_max3_u32 v7, v7, v154, v155
  s_waitcnt vmcnt(2) lgkmcnt(4)
  v_mfma_f32_32x32x16_bf16 v[88:103], v[36:39], v[156:159], v[88:103]
  v_max3_u32 v7, v7, v156, v157
  v_max3_u32 v7, v7, v158, v159
  s_waitcnt vmcnt(1) lgkmcnt(2)
  v_mfma_f32_32x32x16_bf16 v[88:103], v[40:43], v[160:163], v[88:103]
  v_max3_u32 v7, v7, v160, v161
  v_max3_u32 v7, v7, v162, v163
  s_waitcnt vmcnt(0) lgkmcnt(0)
  v_mfma_f32_32x32x16_bf16 v[88:103], v[28:31], v[164:167], v[88:103]
  v_max3_u32 v7, v7, v164, v165
  v_max3_u32 v7, v7, v166, v167
  v_cmp_ne_u32 vcc, -1, v7
  s_cmp_eq_u64 vcc, exec
  s_cbranch_scc1 K_oddok
  s_sub_u32 s38, s38, 1
  s_cmp_lg_u32 s38, 0
  s_cbranch_scc1 K_oddr
K_oddok:
  s_waitcnt vmcnt(0)
  v_permlane32_swap_b32 v12, v14
  v_permlane32_swap_b32 v13, v15
  v_permlane32_swap_b32 v16, v18
  v_permlane32_swap_b32 v17, v19
  v_mov_b32 v60, 0
  v_mov_b32 v61, 0
  v_mov_b32 v62, 0
  s_nop 5
  v_cvt_pk_bf16_f32 v6, v88, v89
  v_lshlrev_b32 v88, 16, v6
  v_and_b32 v89, s44, v6
  v_lshlrev_b32 v7, 16, v12
  v_and_b32 v63, s44, v12
  v_add_f32 v88, v88, v7
  v_add_f32 v89, v89, v63
  v_cvt_pk_bf16_f32 v64, v88, v89
  v_cvt_pk_bf16_f32 v6, v90, v91
  v_lshlrev_b32 v90, 16, v6
  v_and_b32 v91, s44, v6
  v_lshlrev_b32 v7, 16, v13
  v_and_b32 v63, s44, v13
  v_add_f32 v90, v90, v7
  v_add_f32 v91, v91, v63
  v_cvt_pk_bf16_f32 v65, v90, v91
  v_cvt_pk_bf16_f32 v6, v92, v93
  v_lshlrev_b32 v92, 16, v6
  v_and_b32 v93, s44, v6
  v_lshlrev_b32 v7, 16, v14
  v_and_b32 v63, s44, v14
  v_add_f32 v92, v92, v7
  v_add_f32 v93, v93, v63
  v_cvt_pk_bf16_f32 v66, v92, v93
  v_cvt_pk_bf16_f32 v6, v94, v95
  v_lshlrev_b32 v94, 16, v6
  v_and_b32 v95, s44, v6
  v_lshlrev_b32 v7, 16, v15
  v_and_b32 v63, s44, v15
  v_add_f32 v94, v94, v7
  v_add_f32 v95, v95, v63
  v_cvt_pk_bf16_f32 v67, v94, v95
  v_cvt_pk_bf16_f32 v6, v96, v97
  v_lshlrev_b32 v96, 16, v6
  v_and_b32 v97, s44, v6
  v_lshlrev_b32 v7, 16, v16
  v_and_b32 v63, s44, v16
  v_add_f32 v96, v96, v7
  v_add_f32 v97, v97, v63
  v_cvt_pk_bf16_f32 v68, v96, v97
  v_cvt_pk_bf16_f32 v6, v98, v99
  v_lshlrev_b32 v98, 16, v6
  v_and_b32 v99, s44, v6
  v_lshlrev_b32 v7, 16, v17
  v_and_b32 v63, s44, v17
  v_add_f32 v98, v98, v7
  v_add_f32 v99, v99, v63
  v_cvt_pk_bf16_f32 v69, v98, v99
  v_cvt_pk_bf16_f32 v6, v100, v101
  v_lshlrev_b32 v100, 16, v6
  v_and_b32 v101, s44, v6
  v_lshlrev_b32 v7, 16, v18
  v_and_b32 v63, s44, v18
  v_add_f32 v100, v100, v7
  v_add_f32 v101, v101, v63
  v_cvt_pk_bf16_f32 v70, v100, v101
  v_cvt_pk_bf16_f32 v6, v102, v103
  v_lshlrev_b32 v102, 16, v6
  v_and_b32 v103, s44, v6
  v_lshlrev_b32 v7, 16, v19
  v_and_b32 v63, s44, v19
  v_add_f32 v102, v102, v7
  v_add_f32 v103, v103, v63
  v_cvt_pk_bf16_f32 v71, v102, v103
  v_dot2_f32_bf16 v60, v64, v11, v60
  v_dot2_f32_bf16 v61, v64, v64, v61
  v_dot2_f32_bf16 v62, v64, v20, v62
  v_dot2_f32_bf16 v60, v65, v11, v60
  v_dot2_f32_bf16 v61, v65, v65, v61
  v_dot2_f32_bf16 v62, v65, v21, v62
  v_dot2_f32_bf16 v60, v66, v11, v60
  v_dot2_f32_bf16 v61, v66, v66, v61
  v_dot2_f32_bf16 v62, v66, v22, v62
  v_dot2_f32_bf16 v60, v67, v11, v60
  v_dot2_f32_bf16 v61, v67, v67, v61
  v_dot2_f32_bf16 v62, v67, v23, v62
  v_dot2_f32_bf16 v60, v68, v11, v60
  v_dot2_f32_bf16 v61, v68, v68, v61
  v_dot2_f32_bf16 v62, v68, v24, v62
  v_dot2_f32_bf16 v60, v69, v11, v60
  v_dot2_f32_bf16 v61, v69, v69, v61
  v_dot2_f32_bf16 v62, v69, v25, v62
  v_dot2_f32_bf16 v60, v70, v11, v60
  v_dot2_f32_bf16 v61, v70, v70, v61
  v_dot2_f32_bf16 v62, v70, v26, v62
  v_dot2_f32_bf16 v60, v71, v11, v60
  v_dot2_f32_bf16 v61, v71, v71, v61
  v_dot2_f32_bf16 v62, v71, v27, v62
  s_lshl_b32 s3, s34, 9
  s_add_u32 s3, s3, 9472
  v_lshlrev_b32 v6, 4, v9
  v_add_u32 v7, s3, v6
  v_mov_b32 v92, v60
  v_mov_b32 v93, v61
  v_mov_b32 v94, v62
  s_nop 1
  v_permlane32_swap_b32 v60, v92
  v_permlane32_swap_b32 v61, v93
  v_permlane32_swap_b32 v62, v94
  s_nop 1
  v_add_f32 v88, v60, v92
  v_add_f32 v89, v61, v93
  v_add_f32 v90, v62, v94
  v_mov_b32 v91, 1
  s_lshl_b32 s40, s21, 3
  s_add_u32 s40, s40, s22
  s_lshl_b32 s40, s40, 10
  s_lshl_b32 s3, s34, 9
  s_add_u32 s40, s40, s3
  s_add_u32 s40, s40, 12845056
  s_cmp_eq_u32 s35, 0
  s_cbranch_scc1 K_g0
  ds_write_b128 v7, v[88:91]
  s_branch K_g1
K_g0:
  s_mov_b32 s38, 1600000
K_gx:
  ds_read_b128 v[92:95], v7 offset:0
  s_waitcnt lgkmcnt(0)
  v_cmp_ne_u32 vcc, 0, v95
  s_cmp_eq_u64 vcc, exec
  s_cbranch_scc1 K_gx_ok
  s_sub_u32 s38, s38, 1
  s_cmp_lg_u32 s38, 0
  s_cbranch_scc1 K_gx
K_gx_ok:
  v_add_f32 v88, v88, v92
  v_add_f32 v89, v89, v93
  v_add_f32 v90, v90, v94
  v_or_b32 v88, 1, v88
  v_or_b32 v89, 1, v89
  v_or_b32 v90, 1, v90
  s_mov_b32 exec_hi, 0
  s_cmp_eq_u32 s55, 1
  s_cbranch_scc0 K_sl_9
  buffer_store_dwordx4 v[88:91], v6, s[24:27], s40 offen
  s_branch K_sj_10
K_sl_9:
  buffer_store_dwordx4 v[88:91], v6, s[24:27], s40 offen sc1
K_sj_10:
  s_mov_b64 exec, -1
K_g1:
  v_permlane32_swap_b32 v64, v66
  v_permlane32_swap_b32 v65, v67
  v_permlane32_swap_b32 v68, v70
  v_permlane32_swap_b32 v69, v71
  s_mov_b32 s12, s6
  s_mov_b32 s13, s7
  s_mov_b32 s14, 2097152
  s_mov_b32 s15, 0x20000
  v_and_b32 v6, 7, v1
  v_lshlrev_b32 v0, 2, v6
  v_lshlrev_b32 v3, 3, v9
  s_lshl_b32 s42, s36, 5
  s_sub_u32 s42, 2047, s42
  v_sub_u32 v63, s42, v9
  s_lshl_b32 s33, s21, 14
  s_add_u32 s33, s33, s39
  s_add_u32 s33, s33, 8388608
  s_lshl_b32 s3, s34, 8
  v_add_u32 v3, s3, v3
  s_mov_b32 s38, 1600000
K_lcd:
  ds_read_b32 v12, v0 offset:15104
  s_waitcnt lgkmcnt(0)
  v_cmp_ne_u32 vcc, 0, v12
  s_cmp_eq_u64 vcc, exec
  s_cbranch_scc1 K_lcd_ok
  s_sleep 1
  s_sub_u32 s38, s38, 1
  s_cmp_lg_u32 s38, 0
  s_cbranch_scc1 K_lcd
K_lcd_ok:
  ds_read_b64 v[60:61], v3 offset:14592
  s_waitcnt lgkmcnt(0)
  v_and_b32 v60, s44, v60
  v_and_b32 v12, 0x7ff, v12
  v_lshlrev_b32 v6, 16, v64
  v_and_b32 v7, s44, v64
  v_subrev_f32 v6, v60, v6
  v_subrev_f32 v7, v60, v7
  v_cvt_pk_bf16_f32 v72, v6, v7
  v_lshlrev_b32 v6, 16, v72
  v_and_b32 v7, s44, v72
  v_mul_f32 v6, v61, v6
  v_mul_f32 v7, v61, v7
  v_cvt_pk_bf16_f32 v72, v6, v7
  v_lshlrev_b32 v6, 16, v65
  v_and_b32 v7, s44, v65
  v_subrev_f32 v6, v60, v6
  v_subrev_f32 v7, v60, v7
  v_cvt_pk_bf16_f32 v73, v6, v7
  v_lshlrev_b32 v6, 16, v73
  v_and_b32 v7, s44, v73
  v_mul_f32 v6, v61, v6
  v_mul_f32 v7, v61, v7
  v_cvt_pk_bf16_f32 v73, v6, v7
  v_lshlrev_b32 v6, 16, v66
  v_and_b32 v7, s44, v66
  v_subrev_f32 v6, v60, v6
  v_subrev_f32 v7, v60, v7
  v_cvt_pk_bf16_f32 v74, v6, v7
  v_lshlrev_b32 v6, 16, v74
  v_and_b32 v7, s44, v74
  v_mul_f32 v6, v61, v6
  v_mul_f32 v7, v61, v7
  v_cvt_pk_bf16_f32 v74, v6, v7
  v_lshlrev_b32 v6, 16, v67
  v_and_b32 v7, s44, v67
  v_subrev_f32 v6, v60, v6
  v_subrev_f32 v7, v60, v7
  v_cvt_pk_bf16_f32 v75, v6, v7
  v_lshlrev_b32 v6, 16, v75
  v_and_b32 v7, s44, v75
  v_mul_f32 v6, v61, v6
  v_mul_f32 v7, v61, v7
  v_cvt_pk_bf16_f32 v75, v6, v7
  v_lshlrev_b32 v6, 16, v68
  v_and_b32 v7, s44, v68
  v_subrev_f32 v6, v60, v6
  v_subrev_f32 v7, v60, v7
  v_cvt_pk_bf16_f32 v76, v6, v7
  v_lshlrev_b32 v6, 16, v76
  v_and_b32 v7, s44, v76
  v_mul_f32 v6, v61, v6
  v_mul_f32 v7, v61, v7
  v_cvt_pk_bf16_f32 v76, v6, v7
  v_lshlrev_b32 v6, 16, v69
  v_and_b32 v7, s44, v69
  v_subrev_f32 v6, v60, v6
  v_subrev_f32 v7, v60, v7
  v_cvt_pk_bf16_f32 v77, v6, v7
  v_lshlrev_b32 v6, 16, v77
  v_and_b32 v7, s44, v77
  v_mul_f32 v6, v61, v6
  v_mul_f32 v7, v61, v7
  v_cvt_pk_bf16_f32 v77, v6, v7
  v_lshlrev_b32 v6, 16, v70
  v_and_b32 v7, s44, v70
  v_subrev_f32 v6, v60, v6
  v_subrev_f32 v7, v60, v7
  v_cvt_pk_bf16_f32 v78, v6, v7
  v_lshlrev_b32 v6, 16, v78
  v_and_b32 v7, s44, v78
  v_mul_f32 v6, v61, v6
  v_mul_f32 v7, v61, v7
  v_cvt_pk_bf16_f32 v78, v6, v7
  v_lshlrev_b32 v6, 16, v71
  v_and_b32 v7, s44, v71
  v_subrev_f32 v6, v60, v6
  v_subrev_f32 v7, v60, v7
  v_cvt_pk_bf16_f32 v79, v6, v7
  v_lshlrev_b32 v6, 16, v79
  v_and_b32 v7, s44, v79
  v_mul_f32 v6, v61, v6
  v_mul_f32 v7, v61, v7
  v_cvt_pk_bf16_f32 v79, v6, v7
  v_readlane_b32 s48, v12, 0
  v_readlane_b32 s49, v12, 1
  v_readlane_b32 s50, v12, 2
  v_readlane_b32 s51, v12, 3
  v_readlane_b32 s52, v12, 4
  v_readlane_b32 s53, v12, 5
  v_readlane_b32 s54, v12, 6
  v_readlane_b32 s55, v12, 7
  v_lshlrev_b32 v13, 4, v8
  s_mov_b64 s[40:41], 0
  v_cmp_eq_u32 vcc, s48, v63
  v_add_u32 v6, 0, v13
  s_or_b64 s[40:41], s[40:41], vcc
  v_cndmask_b32 v13, v13, v6, vcc
  v_cmp_eq_u32 vcc, s49, v63
  v_add_u32 v6, 2048, v13
  s_or_b64 s[40:41], s[40:41], vcc
  v_cndmask_b32 v13, v13, v6, vcc
  v_cmp_eq_u32 vcc, s50, v63
  v_add_u32 v6, 4096, v13
  s_or_b64 s[40:41], s[40:41], vcc
  v_cndmask_b32 v13, v13, v6, vcc
  v_cmp_eq_u32 vcc, s51, v63
  v_add_u32 v6, 6144, v13
  s_or_b64 s[40:41], s[40:41], vcc
  v_cndmask_b32 v13, v13, v6, vcc
  v_cmp_eq_u32 vcc, s52, v63
  v_add_u32 v6, 8192, v13
  s_or_b64 s[40:41], s[40:41], vcc
  v_cndmask_b32 v13, v13, v6, vcc
  v_cmp_eq_u32 vcc, s53, v63
  v_add_u32 v6, 10240, v13
  s_or_b64 s[40:41], s[40:41], vcc
  v_cndmask_b32 v13, v13, v6, vcc
  v_cmp_eq_u32 vcc, s54, v63
  v_add_u32 v6, 12288, v13
  s_or_b64 s[40:41], s[40:41], vcc
  v_cndmask_b32 v13, v13, v6, vcc
  v_cmp_eq_u32 vcc, s55, v63
  v_add_u32 v6, 14336, v13
  s_or_b64 s[40:41], s[40:41], vcc
  v_cndmask_b32 v13, v13, v6, vcc
  s_cmp_eq_u64 s[40:41], 0
  s_cbranch_scc1 K_nocand
  s_mov_b64 exec, s[40:41]
  v_min_u32 v20, 0xfffffffe, v72
  v_min_u32 v28, 0xfffffffe, v64
  v_min_u32 v21, 0xfffffffe, v73
  v_min_u32 v29, 0xfffffffe, v65
  v_min_u32 v22, 0xfffffffe, v74
  v_min_u32 v30, 0xfffffffe, v66
  v_min_u32 v23, 0xfffffffe, v75
  v_min_u32 v31, 0xfffffffe, v67
  v_min_u32 v24, 0xfffffffe, v76
  v_min_u32 v32, 0xfffffffe, v68
  v_min_u32 v25, 0xfffffffe, v77
  v_min_u32 v33, 0xfffffffe, v69
  v_min_u32 v26, 0xfffffffe, v78
  v_min_u32 v34, 0xfffffffe, v70
  v_min_u32 v27, 0xfffffffe, v79
  v_min_u32 v35, 0xfffffffe, v71
  buffer_store_dwordx4 v[20:23], v13, s[24:27], s33 offen sc1
  buffer_store_dwordx4 v[24:27], v13, s[24:27], s33 offen offset:32 sc1
  buffer_store_dwordx4 v[28:31], v13, s[24:27], s33 offen offset:1024 sc1
  buffer_store_dwordx4 v[32:35], v13, s[24:27], s33 offen offset:1056 sc1
  s_mov_b64 exec, -1
K_nocand:
  v_lshlrev_b32 v6, 16, v72
  v_and_b32 v7, s44, v72
  v_lshlrev_b32 v3, 16, v64
  v_and_b32 v88, s44, v64
  v_add_f32 v6, v6, v3
  v_add_f32 v7, v7, v88
  v_cvt_pk_bf16_f32 v72, v6, v7
  v_lshlrev_b32 v6, 16, v73
  v_and_b32 v7, s44, v73
  v_lshlrev_b32 v3, 16, v65
  v_and_b32 v88, s44, v65
  v_add_f32 v6, v6, v3
  v_add_f32 v7, v7, v88
  v_cvt_pk_bf16_f32 v73, v6, v7
  v_lshlrev_b32 v6, 16, v74
  v_and_b32 v7, s44, v74
  v_lshlrev_b32 v3, 16, v66
  v_and_b32 v88, s44, v66
  v_add_f32 v6, v6, v3
  v_add_f32 v7, v7, v88
  v_cvt_pk_bf16_f32 v74, v6, v7
  v_lshlrev_b32 v6, 16, v75
  v_and_b32 v7, s44, v75
  v_lshlrev_b32 v3, 16, v67
  v_and_b32 v88, s44, v67
  v_add_f32 v6, v6, v3
  v_add_f32 v7, v7, v88
  v_cvt_pk_bf16_f32 v75, v6, v7
  v_lshlrev_b32 v6, 16, v76
  v_and_b32 v7, s44, v76
  v_lshlrev_b32 v3, 16, v68
  v_and_b32 v88, s44, v68
  v_add_f32 v6, v6, v3
  v_add_f32 v7, v7, v88
  v_cvt_pk_bf16_f32 v76, v6, v7
  v_lshlrev_b32 v6, 16, v77
  v_and_b32 v7, s44, v77
  v_lshlrev_b32 v3, 16, v69
  v_and_b32 v88, s44, v69
  v_add_f32 v6, v6, v3
  v_add_f32 v7, v7, v88
  v_cvt_pk_bf16_f32 v77, v6, v7
  v_lshlrev_b32 v6, 16, v78
  v_and_b32 v7, s44, v78
  v_lshlrev_b32 v3, 16, v70
  v_and_b32 v88, s44, v70
  v_add_f32 v6, v6, v3
  v_add_f32 v7, v7, v88
  v_cvt_pk_bf16_f32 v78, v6, v7
  v_lshlrev_b32 v6, 16, v79
  v_and_b32 v7, s44, v79
  v_lshlrev_b32 v3, 16, v71
  v_and_b32 v88, s44, v71
  v_add_f32 v6, v6, v3
  v_add_f32 v7, v7, v88
  v_cvt_pk_bf16_f32 v79, v6, v7
  s_andn2_b64 exec, exec, s[40:41]
  buffer_store_dwordx4 v[72:75], v10, s[12:15], s37 offen
  buffer_store_dwordx4 v[76:79], v10, s[12:15], s37 offen offset:32
  s_mov_b64 exec, -1
  s_cmp_eq_u64 s[40:41], 0
  s_cbranch_scc1 K_cdone
  s_mov_b32 s38, 1600000
K_oi:
  ds_read_b32 v14, v0 offset:9152
  s_waitcnt lgkmcnt(0)
  v_cmp_ne_u32 vcc, 0, v14
  s_cmp_eq_u64 vcc, exec
  s_cbranch_scc1 K_oi_ok
  s_sleep 4
  s_sub_u32 s38, s38, 1
  s_cmp_lg_u32 s38, 0
  s_cbranch_scc1 K_oi
K_oi_ok:
  v_and_b32 v14, 0x7ff, v14
  s_nop 0
  v_readlane_b32 s48, v14, 0
  v_readlane_b32 s49, v14, 1
  v_readlane_b32 s50, v14, 2
  v_readlane_b32 s51, v14, 3
  v_readlane_b32 s52, v14, 4
  v_readlane_b32 s53, v14, 5
  v_readlane_b32 s54, v14, 6
  v_readlane_b32 s55, v14, 7
  s_nop 1
  v_cmp_eq_u32 vcc, s48, v63
  s_andn2_b64 s[40:41], s[40:41], vcc
  v_cmp_eq_u32 vcc, s49, v63
  s_andn2_b64 s[40:41], s[40:41], vcc
  v_cmp_eq_u32 vcc, s50, v63
  s_andn2_b64 s[40:41], s[40:41], vcc
  v_cmp_eq_u32 vcc, s51, v63
  s_andn2_b64 s[40:41], s[40:41], vcc
  v_cmp_eq_u32 vcc, s52, v63
  s_andn2_b64 s[40:41], s[40:41], vcc
  v_cmp_eq_u32 vcc, s53, v63
  s_andn2_b64 s[40:41], s[40:41], vcc
  v_cmp_eq_u32 vcc, s54, v63
  s_andn2_b64 s[40:41], s[40:41], vcc
  v_cmp_eq_u32 vcc, s55, v63
  s_andn2_b64 s[40:41], s[40:41], vcc
  s_cmp_eq_u64 s[40:41], 0
  s_cbranch_scc1 K_cdone
  s_mov_b64 exec, s[40:41]
  buffer_store_dwordx4 v[72:75], v10, s[12:15], s37 offen
  buffer_store_dwordx4 v[76:79], v10, s[12:15], s37 offen offset:32
  s_mov_b64 exec, -1
K_cdone:
  s_endpgm
K_ffnw:
  s_lshl_b32 s3, s43, 2
  v_mov_b32 v6, s3
  v_mov_b32 v7, 1
  ds_write_b32 v6, v7 offset:9232
  s_cmp_ge_u32 s61, 119
  s_cbranch_scc1 K_end
  s_and_b32 s35, s43, 1
  v_lshrrev_b32 v6, 4, v1
  v_bfe_u32 v7, v1, 2, 2
  v_and_b32 v10, 3, v1
  v_lshl_add_u32 v8, v6, 3, v7
  v_lshlrev_b32 v8, 5, v8
  v_lshl_add_u32 v8, v10, 3, v8
  s_lshl_b32 s3, s43, 13
  s_add_u32 s3, s3, 131072
  v_add_u32 v8, s3, v8
  v_lshl_add_u32 v9, v6, 3, v7
  v_lshlrev_b32 v9, 5, v9
  v_lshl_add_u32 v9, v10, 3, v9
  s_lshl_b32 s3, s43, 10
  s_add_u32 s3, s3, 131072
  v_add_u32 v9, s3, v9
  v_and_b32 v7, 7, v1
  v_mul_u32_u24 v10, 1040, v7
  v_lshl_add_u32 v10, v6, 4, v10
  s_lshl_b32 s3, s35, 9
  v_add_u32 v10, s3, v10
  v_lshlrev_b32 v12, 3, v6
  v_lshl_add_u32 v12, v7, 5, v12
  v_lshlrev_b32 v11, 2, v7
  s_mul_i32 s3, s43, 2080
  v_add_u32 v13, s3, v2
  v_mov_b32 v15, 0
  s_waitcnt lgkmcnt(0)
  s_mov_b32 s28, s10
  s_mov_b32 s29, s11
  s_mov_b32 s30, 1024
  s_mov_b32 s31, 0x20000
  s_mov_b32 s12, s6
  s_mov_b32 s13, s7
  s_mov_b32 s14, 2097152
  s_mov_b32 s15, 0x20000
  s_mov_b32 s38, 1600000
K_frdy:
  ds_read_b32 v6, v15 offset:9092
  s_waitcnt lgkmcnt(0)
  v_cmp_ne_u32 vcc, 0, v6
  s_cmp_eq_u64 vcc, exec
  s_cbranch_scc1 K_frdy_ok
  s_sleep 2
  s_sub_u32 s38, s38, 1
  s_cmp_lg_u32 s38, 0
  s_cbranch_scc1 K_frdy
K_frdy_ok:
  s_cmp_ge_u32 s61, 86
  s_cbranch_scc1 K_pre2
  ds_read_b64_tr_b16 v[16:17], v8 offset:0
  ds_read_b64_tr_b16 v[18:19], v8 offset:128
  ds_read_b64_tr_b16 v[20:21], v8 offset:1024
  ds_read_b64_tr_b16 v[22:23], v8 offset:1152
  ds_read_b64_tr_b16 v[24:25], v8 offset:2048
  ds_read_b64_tr_b16 v[26:27], v8 offset:2176
  ds_read_b64_tr_b16 v[28:29], v8 offset:3072
  ds_read_b64_tr_b16 v[30:31], v8 offset:3200
  s_waitcnt lgkmcnt(4)
  ds_read_b64_tr_b16 v[32:33], v8 offset:4096
  ds_read_b64_tr_b16 v[34:35], v8 offset:4224
  ds_read_b64_tr_b16 v[36:37], v8 offset:5120
  ds_read_b64_tr_b16 v[38:39], v8 offset:5248
  ds_read_b64_tr_b16 v[40:41], v8 offset:6144
  ds_read_b64_tr_b16 v[42:43], v8 offset:6272
  ds_read_b64_tr_b16 v[44:45], v8 offset:7168
  ds_read_b64_tr_b16 v[46:47], v8 offset:7296
  s_waitcnt lgkmcnt(4)
  s_branch K_nopre
K_pre2:
  v_subrev_u32 v8, 114688, v9
  ds_read_b64_tr_b16 v[16:17], v9 offset:0
  ds_read_b64_tr_b16 v[18:19], v9 offset:128
  ds_read_b64_tr_b16 v[20:21], v9 offset:4096
  ds_read_b64_tr_b16 v[22:23], v9 offset:4224
  ds_read_b64_tr_b16 v[24:25], v9 offset:8192
  ds_read_b64_tr_b16 v[26:27], v9 offset:8320
  ds_read_b64_tr_b16 v[28:29], v9 offset:12288
  ds_read_b64_tr_b16 v[30:31], v9 offset:12416
  s_waitcnt lgkmcnt(4)
  ds_read_b64_tr_b16 v[32:33], v9 offset:16384
  ds_read_b64_tr_b16 v[34:35], v9 offset:16512
  ds_read_b64_tr_b16 v[36:37], v9 offset:20480
  ds_read_b64_tr_b16 v[38:39], v9 offset:20608
  ds_read_b64_tr_b16 v[40:41], v9 offset:24576
  ds_read_b64_tr_b16 v[42:43], v9 offset:24704
  ds_read_b64_tr_b16 v[44:45], v9 offset:28672
  ds_read_b64_tr_b16 v[46:47], v9 offset:28800
  s_waitcnt lgkmcnt(4)
  ds_read_b64_tr_b16 v[48:49], v8 offset:0
  ds_read_b64_tr_b16 v[50:51], v8 offset:128
  ds_read_b64_tr_b16 v[52:53], v8 offset:4096
  ds_read_b64_tr_b16 v[54:55], v8 offset:4224
  ds_read_b64_tr_b16 v[56:57], v8 offset:8192
  ds_read_b64_tr_b16 v[58:59], v8 offset:8320
K_nopre:
  s_waitcnt lgkmcnt(0)
  buffer_load_dwordx4 v[136:139], v2, s[28:31], 0 offen
  s_mov_b32 s38, 1600000
K_fi:
  ds_read_b32 v140, v11 offset:9152
  s_waitcnt lgkmcnt(0)
  v_cmp_ne_u32 vcc, 0, v140
  s_cmp_eq_u64 vcc, exec
  s_cbranch_scc1 K_fi_ok
  s_sleep 1
  s_sub_u32 s38, s38, 1
  s_cmp_lg_u32 s38, 0
  s_cbranch_scc1 K_fi
K_fi_ok:
  v_not_b32 v140, v140
  v_bfe_u32 v141, v140, 11, 3
  v_and_b32 v140, 0x7ff, v140
  v_lshrrev_b32 v6, 6, v140
  v_lshl_add_u32 v141, v6, 3, v141
  v_lshlrev_b32 v141, 11, v141
  s_cmp_gt_u32 s61, 86
  s_cbranch_scc1 K_down
  s_lshl_b32 s3, s43, 1
  s_add_u32 s33, s3, 1
  v_readlane_b32 s46, v141, s3
  v_readlane_b32 s47, v141, s33
  s_nop 3
  s_add_u32 s46, s46, 8388608
  s_add_u32 s47, s47, 8388608
  s_mov_b32 s38, 200000
K_fhn:
  buffer_load_dwordx4 v[64:67], v2, s[24:27], s46 offen sc1
  buffer_load_dwordx4 v[68:71], v2, s[24:27], s47 offen sc1
  s_waitcnt vmcnt(0)
  v_max_u32 v7, v64, v65
  v_max3_u32 v7, v7, v66, v67
  v_max3_u32 v7, v7, v68, v69
  v_max3_u32 v7, v7, v70, v71
  v_cmp_ne_u32 vcc, -1, v7
  s_cmp_eq_u64 vcc, exec
  s_cbranch_scc1 K_fhn_ok
  s_sub_u32 s38, s38, 1
  s_cmp_lg_u32 s38, 0
  s_cbranch_scc1 K_fhn
K_fhn_ok:
  s_cmp_eq_u32 s61, 86
  s_cbranch_scc1 K_sig
  ds_write_b128 v13, v[64:67] offset:0
  ds_write_b128 v13, v[68:71] offset:1040
  s_lshl_b32 s3, s43, 2
  v_mov_b32 v6, s3
  v_mov_b32 v7, 1
  s_waitcnt lgkmcnt(0)
  ds_write_b32 v6, v7 offset:9216
  s_mov_b32 s38, 1600000
K_fx:
  ds_read_b128 v[120:123], v15 offset:9216
  s_waitcnt lgkmcnt(0)
  v_and_b32 v120, v120, v121
  v_and_b32 v122, v122, v123
  v_and_b32 v120, v120, v122
  v_cmp_ne_u32 vcc, 0, v120
  s_cmp_eq_u64 vcc, exec
  s_cbranch_scc1 K_fx_ok
  s_sub_u32 s38, s38, 1
  s_cmp_lg_u32 s38, 0
  s_cbranch_scc1 K_fx
K_fx_ok:
  ds_read_b128 v[84:87], v10 offset:0
  ds_read_b128 v[88:91], v10 offset:64
  ds_read_b128 v[92:95], v10 offset:128
  ds_read_b128 v[96:99], v10 offset:192
  ds_read_b128 v[100:103], v10 offset:256
  ds_read_b128 v[104:107], v10 offset:320
  ds_read_b128 v[108:111], v10 offset:384
  ds_read_b128 v[112:115], v10 offset:448
  s_lshl_b32 s3, s43, 10
  v_add_u32 v6, s3, v2
  s_waitcnt lgkmcnt(7)
  v_mfma_f32_16x16x32_bf16 v[76:79], v[16:19], v[84:87], 0
  s_waitcnt lgkmcnt(6)
  v_mfma_f32_16x16x32_bf16 v[76:79], v[20:23], v[88:91], v[76:79]
  s_waitcnt lgkmcnt(5)
  v_mfma_f32_16x16x32_bf16 v[76:79], v[24:27], v[92:95], v[76:79]
  s_waitcnt lgkmcnt(4)
  v_mfma_f32_16x16x32_bf16 v[76:79], v[28:31], v[96:99], v[76:79]
  s_waitcnt lgkmcnt(3)
  v_mfma_f32_16x16x32_bf16 v[76:79], v[32:35], v[100:103], v[76:79]
  s_waitcnt lgkmcnt(2)
  v_mfma_f32_16x16x32_bf16 v[76:79], v[36:39], v[104:107], v[76:79]
  s_waitcnt lgkmcnt(1)
  v_mfma_f32_16x16x32_bf16 v[76:79], v[40:43], v[108:111], v[76:79]
  s_waitcnt lgkmcnt(0)
  v_mfma_f32_16x16x32_bf16 v[76:79], v[44:47], v[112:115], v[76:79]
  s_lshl_b32 s45, s61, 8
  s_add_u32 s45, s45, 10747904
  s_mov_b32 s40, 0x00ff00ff
  s_mov_b32 s41, 0x00ff00ff
  s_nop 5
  v_or_b32 v76, 1, v76
  v_or_b32 v77, 1, v77
  v_or_b32 v78, 1, v78
  v_or_b32 v79, 1, v79
  ds_write_b128 v6, v[76:79] offset:10496
  s_cmp_lg_u32 s43, 0
  s_cbranch_scc1 K_fdone
  s_mov_b32 s38, 1600000
K_px:
  ds_read_b128 v[120:123], v2 offset:10496
  ds_read_b128 v[124:127], v2 offset:11520
  ds_read_b128 v[128:131], v2 offset:12544
  ds_read_b128 v[132:135], v2 offset:13568
  s_waitcnt lgkmcnt(0)
  v_and_b32 v6, v123, v127
  v_and_b32 v7, v131, v135
  v_and_b32 v6, v6, v7
  v_and_b32 v6, 1, v6
  v_cmp_ne_u32 vcc, 0, v6
  s_cmp_eq_u64 vcc, exec
  s_cbranch_scc1 K_px_ok
  s_sub_u32 s38, s38, 1
  s_cmp_lg_u32 s38, 0
  s_cbranch_scc1 K_px
K_px_ok:
  v_add_f32 v76, v120, v124
  v_add_f32 v128, v128, v132
  v_add_f32 v77, v121, v125
  v_add_f32 v129, v129, v133
  v_add_f32 v78, v122, v126
  v_add_f32 v130, v130, v134
  v_add_f32 v79, v123, v127
  v_add_f32 v131, v131, v135
  v_cvt_pk_bf16_f32 v76, v76, v76
  v_lshlrev_b32 v76, 16, v76
  v_cvt_pk_bf16_f32 v77, v77, v77
  v_lshlrev_b32 v77, 16, v77
  v_cvt_pk_bf16_f32 v78, v78, v78
  v_lshlrev_b32 v78, 16, v78
  v_cvt_pk_bf16_f32 v79, v79, v79
  v_lshlrev_b32 v79, 16, v79
  v_mul_f32 v124, 0xbfb8aa3b, v76
  v_mul_f32 v125, 0xbfb8aa3b, v77
  v_mul_f32 v126, 0xbfb8aa3b, v78
  v_mul_f32 v127, 0xbfb8aa3b, v79
  v_exp_f32 v124, v124
  v_exp_f32 v125, v125
  v_exp_f32 v126, v126
  v_exp_f32 v127, v127
  v_cvt_pk_bf16_f32 v128, v128, v128
  v_lshlrev_b32 v128, 16, v128
  v_cvt_pk_bf16_f32 v129, v129, v129
  v_lshlrev_b32 v129, 16, v129
  v_cvt_pk_bf16_f32 v130, v130, v130
  v_lshlrev_b32 v130, 16, v130
  v_cvt_pk_bf16_f32 v131, v131, v131
  v_lshlrev_b32 v131, 16, v131
  v_add_f32 v124, 1.0, v124
  v_add_f32 v125, 1.0, v125
  v_add_f32 v126, 1.0, v126
  v_add_f32 v127, 1.0, v127
  v_rcp_f32 v124, v124
  v_rcp_f32 v125, v125
  v_rcp_f32 v126, v126
  v_rcp_f32 v127, v127
  s_nop 0
  v_mul_f32 v76, v76, v124
  v_mul_f32 v77, v77, v125
  v_mul_f32 v78, v78, v126
  v_mul_f32 v79, v79, v127
  v_cvt_pk_bf16_f32 v76, v76, v76
  v_lshlrev_b32 v76, 16, v76
  v_cvt_pk_bf16_f32 v77, v77, v77
  v_lshlrev_b32 v77, 16, v77
  v_cvt_pk_bf16_f32 v78, v78, v78
  v_lshlrev_b32 v78, 16, v78
  v_cvt_pk_bf16_f32 v79, v79, v79
  v_lshlrev_b32 v79, 16, v79
  v_mul_f32 v76, v76, v128
  v_mul_f32 v77, v77, v129
  v_mul_f32 v78, v78, v130
  v_mul_f32 v79, v79, v131
  v_cvt_pk_bf16_f32 v76, v76, v77
  v_cvt_pk_bf16_f32 v77, v78, v79
  v_min_u32 v76, 0xfffffffe, v76
  v_min_u32 v77, 0xfffffffe, v77
  s_mov_b64 exec, s[40:41]
  buffer_store_dwordx2 v[76:77], v12, s[24:27], s45 offen sc1
K_fdone:
  s_endpgm
K_sig:
  v_mov_b32 v72, 0
  v_mov_b32 v73, 0
  v_dot2_f32_bf16 v72, v64, v136, v72
  v_dot2_f32_bf16 v73, v68, v136, v73
  v_dot2_f32_bf16 v72, v65, v137, v72
  v_dot2_f32_bf16 v73, v69, v137, v73
  v_dot2_f32_bf16 v72, v66, v138, v72
  v_dot2_f32_bf16 v73, v70, v138, v73
  v_dot2_f32_bf16 v72, v67, v139, v72
  v_dot2_f32_bf16 v73, v71, v139, v73
  s_nop 2
  s_nop 1
  v_add_f32_dpp v72, v72, v72 quad_perm:[1,0,3,2] row_mask:0xf bank_mask:0xf
  v_add_f32_dpp v73, v73, v73 quad_perm:[1,0,3,2] row_mask:0xf bank_mask:0xf
  s_nop 0
  v_add_f32_dpp v72, v72, v72 quad_perm:[2,3,0,1] row_mask:0xf bank_mask:0xf
  v_add_f32_dpp v73, v73, v73 quad_perm:[2,3,0,1] row_mask:0xf bank_mask:0xf
  s_nop 0
  v_add_f32_dpp v72, v72, v72 row_half_mirror row_mask:0xf bank_mask:0xf
  v_add_f32_dpp v73, v73, v73 row_half_mirror row_mask:0xf bank_mask:0xf
  s_nop 0
  v_add_f32_dpp v72, v72, v72 row_mirror row_mask:0xf bank_mask:0xf
  v_add_f32_dpp v73, v73, v73 row_mirror row_mask:0xf bank_mask:0xf
  s_nop 0
  v_mov_b32 v74, v72
  v_mov_b32 v75, v73
  s_nop 1
  v_permlane16_swap_b32 v72, v74
  v_permlane16_swap_b32 v73, v75
  s_nop 1
  v_add_f32 v72, v72, v74
  v_add_f32 v73, v73, v75
  s_nop 0
  v_mov_b32 v74, v72
  v_mov_b32 v75, v73
  s_nop 1
  v_permlane32_swap_b32 v72, v74
  v_permlane32_swap_b32 v73, v75
  s_nop 1
  v_add_f32 v72, v72, v74
  v_add_f32 v73, v73, v75
  s_nop 0
  v_cvt_pk_bf16_f32 v72, v72, v72
  v_lshlrev_b32 v72, 16, v72
  v_mul_f32 v72, 0xbfb8aa3b, v72
  v_exp_f32 v72, v72
  s_nop 0
  v_add_f32 v72, 1.0, v72
  v_rcp_f32 v72, v72
  s_nop 0
  v_cvt_pk_bf16_f32 v72, v72, v72
  v_lshlrev_b32 v72, 16, v72
  v_or_b32 v72, 1, v72
  v_cvt_pk_bf16_f32 v73, v73, v73
  v_lshlrev_b32 v73, 16, v73
  v_mul_f32 v73, 0xbfb8aa3b, v73
  v_exp_f32 v73, v73
  s_nop 0
  v_add_f32 v73, 1.0, v73
  v_rcp_f32 v73, v73
  s_nop 0
  v_cvt_pk_bf16_f32 v73, v73, v73
  v_lshlrev_b32 v73, 16, v73
  v_or_b32 v73, 1, v73
  s_lshl_b32 s33, s43, 3
  s_add_u32 s33, s33, 12816384
  s_mov_b64 exec, 1
  buffer_store_dwordx2 v[72:73], v15, s[24:27], s33 offen sc1
  s_endpgm
K_down:
  s_sub_u32 s62, s61, 87
  v_lshrrev_b32 v6, 4, v1
  v_lshl_add_u32 v114, v6, 3, v141
  v_lshlrev_b32 v112, 10, v140
  v_lshl_add_u32 v112, v6, 3, v112
  s_lshl_b32 s46, s62, 5
  s_add_u32 s47, s46, 8388608
  s_lshl_b32 s45, s43, 9
  s_add_u32 s45, s45, 10747904
  s_add_u32 s48, s45, 8192
  s_add_u32 s49, s45, 16384
  s_mov_b32 s50, 12816384
  s_cmp_lg_u32 s43, 3
  s_cbranch_scc1 K_d1
  v_mov_b32 v56, 0
  v_mov_b32 v57, 0
  v_mov_b32 v58, 0
  v_mov_b32 v59, 0
K_d1:
  s_cmp_eq_u32 s43, 3
  s_cselect_b32 s51, 512, 0
  s_add_u32 s39, s49, 4096
  s_sub_u32 s39, s39, s51
  v_lshrrev_b32 v12, 5, v1
  v_lshlrev_b32 v12, 8, v12
  v_lshl_add_u32 v12, v11, 3, v12
  v_and_b32 v6, 1, v6
  v_lshl_add_u32 v12, v6, 4, v12
  v_add_u32 v13, 4096, v12
  s_mov_b32 s38, 200000
K_psg:
  buffer_load_dword v113, v11, s[24:27], s50 offen sc1
  s_waitcnt vmcnt(0)
  v_and_b32 v7, 1, v113
  v_cmp_ne_u32 vcc, 0, v7
  s_cmp_eq_u64 vcc, exec
  s_cbranch_scc1 K_psg_ok
  s_sleep 1
  s_sub_u32 s38, s38, 1
  s_cmp_lg_u32 s38, 0
  s_cbranch_scc1 K_psg
K_psg_ok:
  buffer_load_dwordx2 v[108:109], v114, s[24:27], s47 offen sc1
  buffer_load_dwordx2 v[110:111], v114, s[24:27], s47 offen offset:1024 sc1
  s_mov_b32 s38, 200000
K_pact:
  buffer_load_dwordx4 v[64:67], v12, s[24:27], s45 offen offset:0 sc1
  buffer_load_dwordx4 v[68:71], v12, s[24:27], s45 offen offset:2048 sc1
  buffer_load_dwordx4 v[72:75], v13, s[24:27], s45 offen offset:0 sc1
  buffer_load_dwordx4 v[76:79], v13, s[24:27], s45 offen offset:2048 sc1
  buffer_load_dwordx4 v[80:83], v12, s[24:27], s48 offen offset:0 sc1
  buffer_load_dwordx4 v[84:87], v12, s[24:27], s48 offen offset:2048 sc1
  buffer_load_dwordx4 v[88:91], v13, s[24:27], s48 offen offset:0 sc1
  buffer_load_dwordx4 v[92:95], v13, s[24:27], s48 offen offset:2048 sc1
  buffer_load_dwordx4 v[96:99], v12, s[24:27], s49 offen offset:0 sc1
  buffer_load_dwordx4 v[100:103], v12, s[24:27], s49 offen offset:2048 sc1
  buffer_load_dwordx4 v[104:107], v12, s[24:27], s39 offen sc1
  s_waitcnt vmcnt(0)
  v_max_u32 v7, v64, v65
  v_max3_u32 v7, v7, v66, v67
  v_max3_u32 v7, v7, v68, v69
  v_max3_u32 v7, v7, v70, v71
  v_max3_u32 v7, v7, v72, v73
  v_max3_u32 v7, v7, v74, v75
  v_max3_u32 v7, v7, v76, v77
  v_max3_u32 v7, v7, v78, v79
  v_max3_u32 v7, v7, v80, v81
  v_max3_u32 v7, v7, v82, v83
  v_max3_u32 v7, v7, v84, v85
  v_max3_u32 v7, v7, v86, v87
  v_max3_u32 v7, v7, v88, v89
  v_max3_u32 v7, v7, v90, v91
  v_max3_u32 v7, v7, v92, v93
  v_max3_u32 v7, v7, v94, v95
  v_max3_u32 v7, v7, v96, v97
  v_max3_u32 v7, v7, v98, v99
  v_max3_u32 v7, v7, v100, v101
  v_max3_u32 v7, v7, v102, v103
  v_max3_u32 v7, v7, v104, v105
  v_max3_u32 v7, v7, v106, v107
  v_cmp_ne_u32 vcc, -1, v7
  s_cmp_eq_u64 vcc, exec
  s_cbranch_scc1 K_pact_ok
  s_sleep 1
  s_sub_u32 s38, s38, 1
  s_cmp_lg_u32 s38, 0
  s_cbranch_scc1 K_pact
K_pact_ok:
  v_mfma_f32_16x16x32_bf16 v[136:139], v[16:19], v[64:67], 0
  v_mfma_f32_16x16x32_bf16 v[136:139], v[20:23], v[68:71], v[136:139]
  v_mfma_f32_16x16x32_bf16 v[136:139], v[24:27], v[72:75], v[136:139]
  v_mfma_f32_16x16x32_bf16 v[136:139], v[28:31], v[76:79], v[136:139]
  v_mfma_f32_16x16x32_bf16 v[136:139], v[32:35], v[80:83], v[136:139]
  v_mfma_f32_16x16x32_bf16 v[136:139], v[36:39], v[84:87], v[136:139]
  v_mfma_f32_16x16x32_bf16 v[136:139], v[40:43], v[88:91], v[136:139]
  v_mfma_f32_16x16x32_bf16 v[136:139], v[44:47], v[92:95], v[136:139]
  v_mfma_f32_16x16x32_bf16 v[136:139], v[48:51], v[96:99], v[136:139]
  v_mfma_f32_16x16x32_bf16 v[136:139], v[52:55], v[100:103], v[136:139]
  v_mfma_f32_16x16x32_bf16 v[136:139], v[56:59], v[104:107], v[136:139]
  s_lshl_b32 s3, s43, 10
  v_add_u32 v6, s3, v2
  s_mov_b32 s40, 0x00ff00ff
  s_mov_b32 s41, 0x00ff00ff
  s_nop 4
  v_or_b32 v136, 1, v136
  v_or_b32 v137, 1, v137
  v_or_b32 v138, 1, v138
  v_or_b32 v139, 1, v139
  ds_write_b128 v6, v[136:139] offset:10496
  s_cmp_lg_u32 s43, 0
  s_cbranch_scc1 K_end
  s_mov_b32 s38, 1600000
K_pxd:
  ds_read_b128 v[120:123], v2 offset:10496
  ds_read_b128 v[124:127], v2 offset:11520
  ds_read_b128 v[128:131], v2 offset:12544
  ds_read_b128 v[132:135], v2 offset:13568
  s_waitcnt lgkmcnt(0)
  v_and_b32 v6, v123, v127
  v_and_b32 v7, v131, v135
  v_and_b32 v6, v6, v7
  v_and_b32 v6, 1, v6
  v_cmp_ne_u32 vcc, 0, v6
  s_cmp_eq_u64 vcc, exec
  s_cbranch_scc1 K_pxd_ok
  s_sub_u32 s38, s38, 1
  s_cmp_lg_u32 s38, 0
  s_cbranch_scc1 K_pxd
K_pxd_ok:
  v_add_f32 v64, v120, v124
  v_add_f32 v68, v128, v132
  v_add_f32 v65, v121, v125
  v_add_f32 v69, v129, v133
  v_add_f32 v66, v122, v126
  v_add_f32 v70, v130, v134
  v_add_f32 v67, v123, v127
  v_add_f32 v71, v131, v135
  v_add_f32 v64, v64, v68
  v_add_f32 v65, v65, v69
  v_add_f32 v66, v66, v70
  v_add_f32 v67, v67, v71
  v_cvt_pk_bf16_f32 v64, v64, v64
  v_lshlrev_b32 v64, 16, v64
  v_cvt_pk_bf16_f32 v65, v65, v65
  v_lshlrev_b32 v65, 16, v65
  v_cvt_pk_bf16_f32 v66, v66, v66
  v_lshlrev_b32 v66, 16, v66
  v_cvt_pk_bf16_f32 v67, v67, v67
  v_lshlrev_b32 v67, 16, v67
  s_waitcnt vmcnt(0)
  v_max_u32 v7, v108, v109
  v_max3_u32 v7, v7, v110, v111
  v_cmp_ne_u32 vcc, -1, v7
  v_and_b32 v6, 1, v113
  v_cmp_ne_u32 s[52:53], 0, v6
  s_and_b64 vcc, vcc, s[52:53]
  s_cmp_eq_u64 vcc, exec
  s_cbranch_scc1 K_pfin_ok
  s_mov_b32 s38, 200000
K_pfin:
  buffer_load_dwordx2 v[108:109], v114, s[24:27], s47 offen sc1
  buffer_load_dwordx2 v[110:111], v114, s[24:27], s47 offen offset:1024 sc1
  buffer_load_dword v113, v11, s[24:27], s50 offen sc1
  s_waitcnt vmcnt(0)
  v_max_u32 v7, v108, v109
  v_max3_u32 v7, v7, v110, v111
  v_cmp_ne_u32 vcc, -1, v7
  v_and_b32 v6, 1, v113
  v_cmp_ne_u32 s[52:53], 0, v6
  s_and_b64 vcc, vcc, s[52:53]
  s_cmp_eq_u64 vcc, exec
  s_cbranch_scc1 K_pfin_ok
  s_sub_u32 s38, s38, 1
  s_cmp_lg_u32 s38, 0
  s_cbranch_scc1 K_pfin
K_pfin_ok:
  v_and_b32 v113, s44, v113
  v_mul_f32 v64, v113, v64
  v_mul_f32 v65, v113, v65
  v_mul_f32 v66, v113, v66
  v_mul_f32 v67, v113, v67
  v_cvt_pk_bf16_f32 v64, v64, v65
  v_cvt_pk_bf16_f32 v65, v66, v67
  v_lshlrev_b32 v68, 16, v64
  v_and_b32 v69, s44, v64
  v_lshlrev_b32 v70, 16, v108
  v_and_b32 v71, s44, v108
  v_add_f32 v68, v68, v70
  v_add_f32 v69, v69, v71
  v_cvt_pk_bf16_f32 v64, v68, v69
  v_lshlrev_b32 v68, 16, v64
  v_and_b32 v69, s44, v64
  v_lshlrev_b32 v70, 16, v110
  v_and_b32 v71, s44, v110
  v_add_f32 v68, v68, v70
  v_add_f32 v69, v69, v71
  v_cvt_pk_bf16_f32 v64, v68, v69
  v_lshlrev_b32 v68, 16, v65
  v_and_b32 v69, s44, v65
  v_lshlrev_b32 v70, 16, v109
  v_and_b32 v71, s44, v109
  v_add_f32 v68, v68, v70
  v_add_f32 v69, v69, v71
  v_cvt_pk_bf16_f32 v65, v68, v69
  v_lshlrev_b32 v68, 16, v65
  v_and_b32 v69, s44, v65
  v_lshlrev_b32 v70, 16, v111
  v_and_b32 v71, s44, v111
  v_add_f32 v68, v68, v70
  v_add_f32 v69, v69, v71
  v_cvt_pk_bf16_f32 v65, v68, v69
  s_mov_b64 exec, s[40:41]
  buffer_store_dwordx2 v[64:65], v112, s[12:15], s46 offen
  s_endpgm
K_wait:
  s_mov_b32 s38, 200000
K_wait2:
  s_sleep 1
  ds_read_b32 v124, v125
  s_waitcnt lgkmcnt(0)
  v_cmp_ne_u32 vcc, 0, v124
  s_cbranch_vccnz K_ready
  s_sub_u32 s38, s38, 1
  s_cmp_lg_u32 s38, 0
  s_cbranch_scc1 K_wait2
  s_branch K_ready
K_fallback:
  v_mov_b32 v119, 0xff800000
  s_mov_b32 s31, 0
K_mx:
  s_lshr_b32 s33, s31, 2
  s_lshl_b32 s33, s33, 14
  s_and_b32 s3, s31, 3
  s_lshl_b32 s3, s3, 11
  s_add_u32 s33, s33, s3
  s_add_u32 s33, s33, s47
  buffer_load_dwordx4 v[88:91], v121, s[24:27], s33 offen sc1
  s_waitcnt vmcnt(0)
  v_mfma_f32_32x32x16_bf16 v[0:15], v[88:91], v[96:99], 0
  s_nop 15
  v_max3_f32 v119, v119, v0, v1
  v_max3_f32 v119, v119, v2, v3
  v_max3_f32 v119, v119, v4, v5
  v_max3_f32 v119, v119, v6, v7
  v_max3_f32 v119, v119, v8, v9
  v_max3_f32 v119, v119, v10, v11
  v_max3_f32 v119, v119, v12, v13
  v_max3_f32 v119, v119, v14, v15
  s_add_u32 s31, s31, 1
  s_cmp_lt_u32 s31, 64
  s_cbranch_scc1 K_mx
  v_mov_b32 v120, v119
  s_nop 1
  v_permlane32_swap_b32 v119, v120
  s_nop 1
  v_max_f32 v119, v119, v120
  v_sub_f32 v48, 0, v119
  v_sub_f32 v49, 0, v119
  v_sub_f32 v50, 0, v119
  v_sub_f32 v51, 0, v119
  v_sub_f32 v52, 0, v119
  v_sub_f32 v53, 0, v119
  v_sub_f32 v54, 0, v119
  v_sub_f32 v55, 0, v119
  v_sub_f32 v56, 0, v119
  v_sub_f32 v57, 0, v119
  v_sub_f32 v58, 0, v119
  v_sub_f32 v59, 0, v119
  v_sub_f32 v60, 0, v119
  v_sub_f32 v61, 0, v119
  v_sub_f32 v62, 0, v119
  v_sub_f32 v63, 0, v119
  v_mov_b32 v32, 0
  v_mov_b32 v33, 0
  v_mov_b32 v34, 0
  v_mov_b32 v35, 0
  v_mov_b32 v36, 0
  v_mov_b32 v37, 0
  v_mov_b32 v38, 0
  v_mov_b32 v39, 0
  v_mov_b32 v40, 0
  v_mov_b32 v41, 0
  v_mov_b32 v42, 0
  v_mov_b32 v43, 0
  v_mov_b32 v44, 0
  v_mov_b32 v45, 0
  v_mov_b32 v46, 0
  v_mov_b32 v47, 0
  s_mov_b32 s31, 0
K_fb2:
  s_lshr_b32 s33, s31, 2
  s_lshl_b32 s33, s33, 14
  s_and_b32 s3, s31, 3
  s_lshl_b32 s3, s3, 11
  s_add_u32 s33, s33, s3
  s_add_u32 s33, s33, s47
  buffer_load_dwordx4 v[88:91], v121, s[24:27], s33 offen sc1
  s_mov_b64 exec, s[40:41]
  buffer_load_dwordx4 v[100:103], v122, s[24:27], s33 offen offset:1024 sc1
  buffer_load_dwordx4 v[108:111], v122, s[24:27], s33 offen offset:1536 sc1
  s_mov_b64 exec, -1
  s_waitcnt vmcnt(0)
  v_mfma_f32_32x32x16_bf16 v[0:15], v[88:91], v[96:99], v[48:63]
  s_nop 15
  v_exp_f32 v64, v0
  v_exp_f32 v65, v1
  v_exp_f32 v66, v2
  v_exp_f32 v67, v3
  v_exp_f32 v68, v4
  v_exp_f32 v69, v5
  v_exp_f32 v70, v6
  v_exp_f32 v71, v7
  v_exp_f32 v72, v8
  v_exp_f32 v73, v9
  v_exp_f32 v74, v10
  v_exp_f32 v75, v11
  v_exp_f32 v76, v12
  v_exp_f32 v77, v13
  v_exp_f32 v78, v14
  v_exp_f32 v79, v15
  s_nop 0
  v_cvt_pk_bf16_f32 v80, v64, v65
  v_cvt_pk_bf16_f32 v81, v66, v67
  v_cvt_pk_bf16_f32 v82, v68, v69
  v_cvt_pk_bf16_f32 v83, v70, v71
  v_cvt_pk_bf16_f32 v84, v72, v73
  v_cvt_pk_bf16_f32 v85, v74, v75
  v_cvt_pk_bf16_f32 v86, v76, v77
  v_cvt_pk_bf16_f32 v87, v78, v79
  s_nop 1
  v_mfma_f32_32x32x16_bf16 v[32:47], v[100:103], v[80:83], v[32:47]
  v_mfma_f32_32x32x16_bf16 v[32:47], v[108:111], v[84:87], v[32:47]
  s_add_u32 s31, s31, 1
  s_cmp_lt_u32 s31, 64
  s_cbranch_scc1 K_fb2
  s_nop 15
  s_branch K_fin
K_stream:
  s_setprio 3
  s_load_dwordx2 s[8:9], s[0:1], 16
  s_load_dwordx2 s[18:19], s[0:1], 32
  s_load_dwordx4 s[12:15], s[0:1], 40
  s_load_dwordx2 s[16:17], s[0:1], 56
  v_lshlrev_b32 v7, 2, v1
  v_lshlrev_b32 v6, 4, v1
  v_mov_b32 v8, 0
  v_mov_b32 v9, 0
  v_mov_b32 v10, 0
  v_mov_b32 v11, 0
  s_lshl_b32 s37, s22, 9
  s_add_u32 s37, s37, 12648448
  s_lshl_b32 s39, s10, 5
  s_lshl_b32 s40, s10, 2
  s_and_b32 s3, s11, 3
  s_add_u32 s40, s40, s3
  s_lshr_b32 s41, s11, 2
  s_getreg_b32 s3, hwreg(HW_REG_XCC_ID, 0, 4)
  s_mul_i32 s33, s3, s3
  s_lshl_b32 s33, s33, 15
  s_lshl_b32 s3, s3, 6
  s_add_u32 s55, s33, s3
  s_add_u32 s55, s55, 1
  s_mov_b32 s44, 0xffff0000
  s_waitcnt lgkmcnt(0)
  s_mov_b32 s24, s58
  s_mov_b32 s25, s59
  s_mov_b32 s26, 13631488
  s_mov_b32 s27, 0x20000
  s_mov_b32 s28, s56
  s_mov_b32 s29, s57
  s_mov_b32 s30, 256
  s_mov_b32 s31, 0x20000
  v_mov_b32 v28, -1
  v_mov_b32 v29, -1
  v_mov_b32 v30, -1
  v_mov_b32 v31, -1
  s_lshl_b32 s42, s40, 3
  s_add_u32 s42, s42, s41
  s_lshl_b32 s33, s42, 10
  s_add_u32 s33, s33, 12845056
  buffer_store_dwordx4 v[8:11], v6, s[24:27], s33 offen sc1
  v_lshrrev_b32 v18, 3, v1
  v_lshlrev_b32 v18, 10, v18
  v_and_b32 v19, 7, v1
  v_lshl_add_u32 v18, v19, 4, v18
  s_lshl_b32 s33, s40, 14
  s_lshl_b32 s3, s41, 7
  s_add_u32 s33, s33, s3
  s_add_u32 s33, s33, 8388608
  buffer_store_dwordx4 v[28:31], v18, s[24:27], s33 offen sc1
  s_add_u32 s33, s33, 8192
  buffer_store_dwordx4 v[28:31], v18, s[24:27], s33 offen sc1
  s_mov_b64 exec, 1
  s_lshl_b32 s33, s21, 4
  s_add_u32 s33, s33, s37
  buffer_store_dwordx4 v[8:11], v8, s[24:27], s33 offen sc1
  s_lshl_b32 s33, s21, 13
  s_lshl_b32 s3, s22, 7
  s_add_u32 s33, s33, s3
  s_add_u32 s33, s33, 13107200
  s_mov_b64 exec, 0xff
  v_lshrrev_b32 v18, 1, v1
  v_lshlrev_b32 v18, 11, v18
  v_and_b32 v19, 1, v1
  v_lshl_add_u32 v18, v19, 6, v18
  buffer_store_dword v8, v18, s[24:27], s33 offen sc1
  s_mov_b64 exec, -1
  s_cmp_lg_u32 s41, 0
  s_cbranch_scc1 K_z1
  s_mov_b64 exec, 0xffff
  v_and_b32 v18, 1, v1
  v_lshrrev_b32 v19, 1, v1
  v_lshlrev_b32 v19, 11, v19
  v_lshl_add_u32 v19, v18, 4, v19
  s_lshl_b32 s33, s40, 5
  s_lshl_b32 s3, s40, 6
  s_add_u32 s3, s3, 13434880
  buffer_store_dwordx4 v[8:11], v19, s[24:27], s3 offen sc1
  s_mov_b64 exec, -1
K_z1:
  s_cmp_gt_u32 s61, 86
  s_cbranch_scc1 K_z3
  s_cmp_eq_u32 s61, 86
  s_cbranch_scc1 K_z2
  s_lshl_b32 s33, s61, 8
  s_add_u32 s33, s33, 10747904
  s_mov_b64 exec, 0xffff
  buffer_store_dwordx4 v[28:31], v6, s[24:27], s33 offen sc1
  s_mov_b64 exec, -1
  s_branch K_z3
K_z2:
  s_mov_b64 exec, 3
  s_mov_b32 s33, 12816384
  buffer_store_dwordx4 v[8:11], v6, s[24:27], s33 offen sc1
  s_mov_b64 exec, -1
K_z3:
  v_mov_b32 v4, s55
  s_mov_b32 s60, 0
  v_lshrrev_b32 v18, 3, v1
  v_lshlrev_b32 v18, 10, v18
  v_bfe_u32 v19, v1, 4, 1
  v_lshlrev_b32 v19, 2, v19
  v_and_b32 v16, 7, v1
  v_xor_b32 v16, v16, v19
  v_lshl_add_u32 v16, v16, 4, v18
  v_lshrrev_b32 v18, 1, v1
  v_mul_u32_u24 v18, 2752, v18
  v_and_b32 v19, 1, v1
  v_lshl_add_u32 v17, v19, 4, v18
  s_cmp_lg_u32 s60, 0
  s_cbranch_scc1 K_ar_11
  s_getreg_b32 s3, hwreg(HW_REG_IB_STS)
  s_and_b32 s3, s3, 0x00c0000f
  s_cbranch_scc1 K_ar_11
  s_waitcnt vmcnt(0)
  s_mov_b64 exec, 1
  buffer_atomic_add v4, v8, s[28:31], s39 offen sc1
  s_mov_b64 exec, -1
  s_mov_b32 s60, 1
K_ar_11:
  s_barrier
  s_cmp_lg_u32 s60, 0
  s_cbranch_scc1 K_ar_12
  s_getreg_b32 s3, hwreg(HW_REG_IB_STS)
  s_and_b32 s3, s3, 0x00c0000f
  s_cbranch_scc1 K_ar_12
  s_waitcnt vmcnt(0)
  s_mov_b64 exec, 1
  buffer_atomic_add v4, v8, s[28:31], s39 offen sc1
  s_mov_b64 exec, -1
  s_mov_b32 s60, 1
K_ar_12:
  s_barrier
  s_cmp_lg_u32 s60, 0
  s_cbranch_scc1 K_ar_13
  s_getreg_b32 s3, hwreg(HW_REG_IB_STS)
  s_and_b32 s3, s3, 0x00c0000f
  s_cbranch_scc1 K_ar_13
  s_waitcnt vmcnt(0)
  s_mov_b64 exec, 1
  buffer_atomic_add v4, v8, s[28:31], s39 offen sc1
  s_mov_b64 exec, -1
  s_mov_b32 s60, 1
K_ar_13:
  s_barrier
  s_cmp_lg_u32 s60, 0
  s_cbranch_scc1 K_ar_14
  s_getreg_b32 s3, hwreg(HW_REG_IB_STS)
  s_and_b32 s3, s3, 0x00c0000f
  s_cbranch_scc1 K_ar_14
  s_waitcnt vmcnt(0)
  s_mov_b64 exec, 1
  buffer_atomic_add v4, v8, s[28:31], s39 offen sc1
  s_mov_b64 exec, -1
  s_mov_b32 s60, 1
K_ar_14:
  s_barrier
  s_cmp_lg_u32 s60, 0
  s_cbranch_scc1 K_ar_15
  s_getreg_b32 s3, hwreg(HW_REG_IB_STS)
  s_and_b32 s3, s3, 0x00c0000f
  s_cbranch_scc1 K_ar_15
  s_waitcnt vmcnt(0)
  s_mov_b64 exec, 1
  buffer_atomic_add v4, v8, s[28:31], s39 offen sc1
  s_mov_b64 exec, -1
  s_mov_b32 s60, 1
K_ar_15:
  s_barrier
  s_cmp_lg_u32 s60, 0
  s_cbranch_scc1 K_ar_16
  s_getreg_b32 s3, hwreg(HW_REG_IB_STS)
  s_and_b32 s3, s3, 0x00c0000f
  s_cbranch_scc1 K_ar_16
  s_waitcnt vmcnt(0)
  s_mov_b64 exec, 1
  buffer_atomic_add v4, v8, s[28:31], s39 offen sc1
  s_mov_b64 exec, -1
  s_mov_b32 s60, 1
K_ar_16:
  s_barrier
  s_cmp_lg_u32 s60, 0
  s_cbranch_scc1 K_ar_17
  s_getreg_b32 s3, hwreg(HW_REG_IB_STS)
  s_and_b32 s3, s3, 0x00c0000f
  s_cbranch_scc1 K_ar_17
  s_waitcnt vmcnt(0)
  s_mov_b64 exec, 1
  buffer_atomic_add v4, v8, s[28:31], s39 offen sc1
  s_mov_b64 exec, -1
  s_mov_b32 s60, 1
K_ar_17:
  s_barrier
  s_cmp_lg_u32 s60, 0
  s_cbranch_scc1 K_ard
  s_waitcnt vmcnt(0)
  s_mov_b64 exec, 1
  buffer_atomic_add v4, v8, s[28:31], s39 offen sc1
  s_mov_b64 exec, -1
  s_mov_b32 s60, 1
K_ard:
  v_and_b32 v19, 7, v1
  v_lshlrev_b32 v19, 5, v19
  s_mov_b32 s38, 200000
K_initw:
  buffer_load_dword v4, v19, s[28:31], 0 offen sc1
  s_waitcnt vmcnt(0)
  v_and_b32 v18, 63, v4
  v_cmp_eq_u32 vcc, 32, v18
  s_cmp_eq_u64 vcc, exec
  s_cbranch_scc1 K_initw_ok
  s_sleep 2
  s_sub_u32 s38, s38, 1
  s_cmp_lg_u32 s38, 0
  s_cbranch_scc1 K_initw
K_initw_ok:
  v_readlane_b32 s3, v4, s10
  s_lshl_b32 s55, s55, 5
  v_mov_b32 v4, s55
  s_nop 1
  v_cmp_eq_u32 vcc, s3, v4
  s_nop 1
  v_cndmask_b32 v18, 2, 1, vcc
  ds_write_b32 v8, v18 offset:8384
  v_readfirstlane_b32 s55, v18
  s_waitcnt lgkmcnt(0)
  s_barrier
  s_barrier
  v_add_u32 v14, 8448, v7
  v_add_u32 v12, 8576, v7
  ds_write_b128 v6, v[8:11] offset:8448
  ds_write_b128 v6, v[8:11] offset:9472
  ds_write_b128 v6, v[8:11] offset:10496
  ds_write_b128 v6, v[8:11] offset:11520
  ds_write_b128 v6, v[8:11] offset:12544
  ds_write_b128 v6, v[8:11] offset:13568
  ds_write_b128 v6, v[8:11] offset:14592
  v_mov_b32 v15, 1
  ds_write_b32 v8, v15 offset:8512
  s_mov_b32 s31, 1
  s_mov_b32 s60, 0
  s_mov_b32 s36, 32768
  s_mov_b32 s28, 0x11111111
  s_mov_b32 s29, 0x11111111
  s_lshl_b32 s3, s21, 2
  s_lshl_b64 s[52:53], 1, s3
  s_andn2_b64 s[28:29], s[28:29], s[52:53]
  s_mov_b32 s63, 2
  s_mov_b32 s38, 200000
  s_waitcnt lgkmcnt(0)
K_round:
  buffer_load_dword v4, v7, s[24:27], s37 offen sc1
  ds_read_b32 v13, v12
  s_waitcnt vmcnt(1)
  v_cmp_gt_u32 vcc, s31, v1
  v_mov_b32 v15, 1
  s_mov_b64 exec, vcc
  ds_write_b32 v14, v15
  s_mov_b64 exec, -1
  s_waitcnt vmcnt(0) lgkmcnt(0)
  v_cmp_ne_u32 s[48:49], 0, v4
  v_cmp_ne_u32 s[50:51], 0, v13
  s_lshr_b64 s[52:53], s[48:49], 1
  s_and_b64 s[48:49], s[48:49], s[52:53]
  s_lshr_b64 s[52:53], s[48:49], 2
  s_and_b64 s[48:49], s[48:49], s[52:53]
  s_cmp_lt_u32 s31, 9
  s_cbranch_scc1 K_nowarm
  s_cmp_ge_u32 s60, 4
  s_cbranch_scc1 K_nowarm
  s_add_u32 s60, s60, 1
  s_cmp_lg_u32 s60, 1
  s_cbranch_scc1 K_nopoi
  s_lshl_b32 s33, s21, 17
  s_lshl_b32 s3, s22, 11
  s_add_u32 s33, s33, s3
  s_add_u32 s33, s33, 6291456
  buffer_store_dwordx4 v[28:31], v6, s[24:27], s33 offen sc1
  buffer_store_dwordx4 v[28:31], v6, s[24:27], s33 offen offset:1024 sc1
  s_add_u32 s33, s33, 32768
  buffer_store_dwordx4 v[28:31], v6, s[24:27], s33 offen sc1
  buffer_store_dwordx4 v[28:31], v6, s[24:27], s33 offen offset:1024 sc1
  s_add_u32 s33, s33, 32768
  buffer_store_dwordx4 v[28:31], v6, s[24:27], s33 offen sc1
  buffer_store_dwordx4 v[28:31], v6, s[24:27], s33 offen offset:1024 sc1
  s_add_u32 s33, s33, 32768
  buffer_store_dwordx4 v[28:31], v6, s[24:27], s33 offen sc1
  buffer_store_dwordx4 v[28:31], v6, s[24:27], s33 offen offset:1024 sc1
  s_add_u32 s33, s33, 32768
K_nopoi:
  s_cmp_eq_u32 s60, 4
  s_cbranch_scc1 K_warmo
  s_cmp_ge_u32 s61, 86
  s_cbranch_scc1 K_warm2
  s_cmp_eq_u32 s60, 3
  s_cbranch_scc1 K_nowarm
  s_cmp_eq_u32 s60, 1
  s_cselect_b32 s4, s12, s14
  s_cselect_b32 s5, s13, s15
  s_mov_b32 s6, 1409024
  s_mov_b32 s7, 0x20000
  v_mul_u32_u24 v18, 2752, v1
  s_lshl_b32 s62, s61, 5
  s_add_u32 s33, s62, 0
  buffer_load_dword v72, v18, s[4:7], s33 offen
  s_add_u32 s33, s62, 176128
  buffer_load_dword v73, v18, s[4:7], s33 offen
  s_add_u32 s33, s62, 352256
  buffer_load_dword v74, v18, s[4:7], s33 offen
  s_add_u32 s33, s62, 528384
  buffer_load_dword v75, v18, s[4:7], s33 offen
  s_add_u32 s33, s62, 704512
  buffer_load_dword v76, v18, s[4:7], s33 offen
  s_add_u32 s33, s62, 880640
  buffer_load_dword v77, v18, s[4:7], s33 offen
  s_add_u32 s33, s62, 1056768
  buffer_load_dword v78, v18, s[4:7], s33 offen
  s_add_u32 s33, s62, 1232896
  buffer_load_dword v79, v18, s[4:7], s33 offen
  s_branch K_nowarm
K_warm2:
  s_sub_u32 s62, s61, 87
  s_cmp_ge_u32 s62, 32
  s_cbranch_scc1 K_nowarm
  s_cmp_lg_u32 s60, 1
  s_cbranch_scc1 K_nowarm
  s_mov_b32 s4, s16
  s_mov_b32 s5, s17
  s_mov_b32 s6, 1409024
  s_mov_b32 s7, 0x20000
  s_and_b32 s3, s62, 3
  s_mul_i32 s3, s3, 352256
  s_lshl_b32 s62, s62, 5
  s_add_u32 s62, s62, s3
  s_branch K_warm3
K_warmo:
  s_mov_b32 s4, s8
  s_mov_b32 s5, s9
  s_mov_b32 s6, 524288
  s_mov_b32 s7, 0x20000
  s_lshl_b32 s62, s41, 7
K_warm3:
  v_lshlrev_b32 v18, 10, v1
  s_add_u32 s33, s62, 0
  buffer_load_dword v72, v18, s[4:7], s33 offen
  s_add_u32 s33, s62, 65536
  buffer_load_dword v73, v18, s[4:7], s33 offen
  s_add_u32 s33, s62, 131072
  buffer_load_dword v74, v18, s[4:7], s33 offen
  s_add_u32 s33, s62, 196608
  buffer_load_dword v75, v18, s[4:7], s33 offen
  s_add_u32 s33, s62, 262144
  buffer_load_dword v76, v18, s[4:7], s33 offen
  s_add_u32 s33, s62, 327680
  buffer_load_dword v77, v18, s[4:7], s33 offen
  s_add_u32 s33, s62, 393216
  buffer_load_dword v78, v18, s[4:7], s33 offen
  s_add_u32 s33, s62, 458752
  buffer_load_dword v79, v18, s[4:7], s33 offen
K_nowarm:
  s_cmp_ge_u32 s31, 16
  s_cbranch_scc1 K_sdone
  s_mov_b32 s46, 0
K_try:
  s_and_b64 s[48:49], s[48:49], s[28:29]
  s_cbranch_scc0 K_rend
  s_lshl_b32 s3, s21, 2
  s_lshr_b64 s[52:53], s[48:49], s3
  s_ff1_i32_b64 s45, s[52:53]
  s_add_u32 s45, s45, s3
  s_ff1_i32_b64 s3, s[48:49]
  s_cmp_eq_u64 s[52:53], 0
  s_cselect_b32 s45, s3, s45
  s_cmp_lt_u32 s31, 9
  s_cbranch_scc1 K_free
  s_sub_u32 s3, s31, 9
  s_lshl_b32 s3, s3, 3
  s_lshr_b64 s[52:53], s[50:51], s3
  s_and_b32 s52, s52, 0xff
  s_cmp_lg_u32 s52, 0xff
  s_cbranch_scc1 K_rend
K_free:
  s_lshl_b64 s[52:53], 1, s45
  s_andn2_b64 s[28:29], s[28:29], s[52:53]
  s_lshl_b32 s33, s45, 12
  s_add_u32 s33, s33, s47
  s_mov_b32 m0, s36
  s_nop 0
  buffer_load_dwordx4 v6, s[24:27], s33 offen offset:0 sc1 lds
  buffer_load_dwordx4 v6, s[24:27], s33 offen offset:1024 sc1 lds
  buffer_load_dwordx4 v6, s[24:27], s33 offen offset:2048 sc1 lds
  buffer_load_dwordx4 v6, s[24:27], s33 offen offset:3072 sc1 lds
  s_add_u32 m0, m0, 4096
  s_add_u32 s33, s33, 4096
  buffer_load_dwordx4 v6, s[24:27], s33 offen offset:0 sc1 lds
  buffer_load_dwordx4 v6, s[24:27], s33 offen offset:1024 sc1 lds
  buffer_load_dwordx4 v6, s[24:27], s33 offen offset:2048 sc1 lds
  buffer_load_dwordx4 v6, s[24:27], s33 offen offset:3072 sc1 lds
  s_add_u32 m0, m0, 4096
  s_add_u32 s33, s33, 4096
  buffer_load_dwordx4 v6, s[24:27], s33 offen offset:0 sc1 lds
  buffer_load_dwordx4 v6, s[24:27], s33 offen offset:1024 sc1 lds
  buffer_load_dwordx4 v6, s[24:27], s33 offen offset:2048 sc1 lds
  buffer_load_dwordx4 v6, s[24:27], s33 offen offset:3072 sc1 lds
  s_add_u32 m0, m0, 4096
  s_add_u32 s33, s33, 4096
  buffer_load_dwordx4 v6, s[24:27], s33 offen offset:0 sc1 lds
  buffer_load_dwordx4 v6, s[24:27], s33 offen offset:1024 sc1 lds
  buffer_load_dwordx4 v6, s[24:27], s33 offen offset:2048 sc1 lds
  buffer_load_dwordx4 v6, s[24:27], s33 offen offset:3072 sc1 lds
  s_add_u32 s36, s36, 16384
  s_cmp_eq_u32 s36, 163840
  s_cselect_b32 s36, 16384, s36
  s_add_u32 s31, s31, 1
  s_add_u32 s46, s46, 1
  s_cmp_lg_u32 s63, 0
  s_cbranch_scc1 K_e2
  s_cmp_ge_u32 s31, 16
  s_cbranch_scc1 K_round
  s_sub_u32 s3, s31, s46
  s_min_u32 s3, s3, 3
  s_cmp_lt_u32 s46, s3
  s_cbranch_scc1 K_try
  s_branch K_round
K_rend:
  s_cmp_eq_u32 s63, 0
  s_cbranch_scc1 K_rend2
  s_sub_u32 s63, s63, 1
  s_cmp_lg_u32 s63, 0
  s_cbranch_scc1 K_round
K_e2:
  s_mov_b32 s63, 0
  s_barrier
  s_branch K_round
K_rend2:
  s_cmp_lg_u32 s46, 0
  s_cbranch_scc1 K_round
  s_sleep 2
  s_sub_u32 s38, s38, 1
  s_cmp_lg_u32 s38, 0
  s_cbranch_scc1 K_round
  v_mov_b32 v15, 1
  s_mov_b32 exec_hi, 0
  ds_write_b32 v14, v15
  s_mov_b64 exec, -1
K_sdone:
  s_cmp_lg_u32 s11, 5
  s_cbranch_scc1 K_nowb1
  buffer_wbl2 sc1
K_nowb1:
  s_mov_b32 s48, s18
  s_mov_b32 s49, s19
  s_mov_b32 s50, 1024
  s_mov_b32 s51, 0x20000
  buffer_load_dwordx4 v[24:27], v6, s[48:51], 0 offen
  v_mov_b32 v18, 0x3f803f80
  v_mov_b32 v20, 0
  s_waitcnt vmcnt(0)
  v_dot2_f32_bf16 v20, v24, v18, v20
  v_dot2_f32_bf16 v20, v25, v18, v20
  v_dot2_f32_bf16 v20, v26, v18, v20
  v_dot2_f32_bf16 v20, v27, v18, v20
  s_nop 2
  s_nop 1
  v_add_f32_dpp v20, v20, v20 quad_perm:[1,0,3,2] row_mask:0xf bank_mask:0xf
  s_nop 1
  v_add_f32_dpp v20, v20, v20 quad_perm:[2,3,0,1] row_mask:0xf bank_mask:0xf
  s_nop 1
  v_add_f32_dpp v20, v20, v20 row_half_mirror row_mask:0xf bank_mask:0xf
  s_nop 1
  v_add_f32_dpp v20, v20, v20 row_mirror row_mask:0xf bank_mask:0xf
  s_nop 1
  v_mov_b32 v18, v20
  s_nop 1
  v_permlane16_swap_b32 v20, v18
  s_nop 1
  v_add_f32 v20, v20, v18
  s_nop 1
  v_mov_b32 v18, v20
  s_nop 1
  v_permlane32_swap_b32 v20, v18
  s_nop 1
  v_add_f32 v20, v20, v18
  s_nop 1
  v_and_b32 v19, 7, v1
  v_lshlrev_b32 v19, 2, v19
  v_mov_b32 v15, 1
  s_cmp_ge_u32 s61, 86
  s_cbranch_scc1 K_job2
  s_lshl_b32 s45, s61, 5
  s_mov_b32 s48, s12
  s_mov_b32 s49, s13
  s_mov_b32 s50, 1409024
  s_mov_b32 s51, 0x20000
  s_mov_b32 s38, 800000
K_wd7:
  ds_read_b32 v4, v19 offset:8800
  s_waitcnt lgkmcnt(0)
  v_cmp_ne_u32 vcc, 0, v4
  s_cmp_eq_u64 vcc, exec
  s_cbranch_scc1 K_wd7_ok
  s_sleep 4
  s_sub_u32 s38, s38, 1
  s_cmp_lg_u32 s38, 0
  s_cbranch_scc1 K_wd7
K_wd7_ok:
  s_mov_b32 m0, 131072
  s_add_u32 s33, s45, 0
  buffer_load_dwordx4 v17, s[48:51], s33 offen lds
  s_mov_b32 m0, 132096
  s_add_u32 s33, s45, 88064
  buffer_load_dwordx4 v17, s[48:51], s33 offen lds
  s_mov_b32 m0, 133120
  s_add_u32 s33, s45, 176128
  buffer_load_dwordx4 v17, s[48:51], s33 offen lds
  s_mov_b32 m0, 134144
  s_add_u32 s33, s45, 264192
  buffer_load_dwordx4 v17, s[48:51], s33 offen lds
  s_mov_b32 m0, 135168
  s_add_u32 s33, s45, 352256
  buffer_load_dwordx4 v17, s[48:51], s33 offen lds
  s_mov_b32 m0, 136192
  s_add_u32 s33, s45, 440320
  buffer_load_dwordx4 v17, s[48:51], s33 offen lds
  s_mov_b32 m0, 137216
  s_add_u32 s33, s45, 528384
  buffer_load_dwordx4 v17, s[48:51], s33 offen lds
  s_mov_b32 m0, 138240
  s_add_u32 s33, s45, 616448
  buffer_load_dwordx4 v17, s[48:51], s33 offen lds
  s_mov_b32 m0, 139264
  s_add_u32 s33, s45, 704512
  buffer_load_dwordx4 v17, s[48:51], s33 offen lds
  s_mov_b32 m0, 140288
  s_add_u32 s33, s45, 792576
  buffer_load_dwordx4 v17, s[48:51], s33 offen lds
  s_mov_b32 m0, 141312
  s_add_u32 s33, s45, 880640
  buffer_load_dwordx4 v17, s[48:51], s33 offen lds
  s_mov_b32 m0, 142336
  s_add_u32 s33, s45, 968704
  buffer_load_dwordx4 v17, s[48:51], s33 offen lds
  s_mov_b32 m0, 143360
  s_add_u32 s33, s45, 1056768
  buffer_load_dwordx4 v17, s[48:51], s33 offen lds
  s_mov_b32 m0, 144384
  s_add_u32 s33, s45, 1144832
  buffer_load_dwordx4 v17, s[48:51], s33 offen lds
  s_mov_b32 m0, 145408
  s_add_u32 s33, s45, 1232896
  buffer_load_dwordx4 v17, s[48:51], s33 offen lds
  s_mov_b32 m0, 146432
  s_add_u32 s33, s45, 1320960
  buffer_load_dwordx4 v17, s[48:51], s33 offen lds
  s_waitcnt vmcnt(16)
  s_mov_b32 s48, s14
  s_mov_b32 s49, s15
  s_mov_b32 s50, 1409024
  s_mov_b32 s51, 0x20000
  s_mov_b32 s38, 800000
K_wd8:
  ds_read_b32 v4, v19 offset:8832
  s_waitcnt lgkmcnt(0)
  v_cmp_ne_u32 vcc, 0, v4
  s_cmp_eq_u64 vcc, exec
  s_cbranch_scc1 K_wd8_ok
  s_sleep 4
  s_sub_u32 s38, s38, 1
  s_cmp_lg_u32 s38, 0
  s_cbranch_scc1 K_wd8
K_wd8_ok:
  s_mov_b32 m0, 147456
  s_add_u32 s33, s45, 0
  buffer_load_dwordx4 v17, s[48:51], s33 offen lds
  s_mov_b32 m0, 148480
  s_add_u32 s33, s45, 88064
  buffer_load_dwordx4 v17, s[48:51], s33 offen lds
  s_mov_b32 m0, 149504
  s_add_u32 s33, s45, 176128
  buffer_load_dwordx4 v17, s[48:51], s33 offen lds
  s_mov_b32 m0, 150528
  s_add_u32 s33, s45, 264192
  buffer_load_dwordx4 v17, s[48:51], s33 offen lds
  s_mov_b32 m0, 151552
  s_add_u32 s33, s45, 352256
  buffer_load_dwordx4 v17, s[48:51], s33 offen lds
  s_mov_b32 m0, 152576
  s_add_u32 s33, s45, 440320
  buffer_load_dwordx4 v17, s[48:51], s33 offen lds
  s_mov_b32 m0, 153600
  s_add_u32 s33, s45, 528384
  buffer_load_dwordx4 v17, s[48:51], s33 offen lds
  s_mov_b32 m0, 154624
  s_add_u32 s33, s45, 616448
  buffer_load_dwordx4 v17, s[48:51], s33 offen lds
  s_mov_b32 m0, 155648
  s_add_u32 s33, s45, 704512
  buffer_load_dwordx4 v17, s[48:51], s33 offen lds
  s_mov_b32 m0, 156672
  s_add_u32 s33, s45, 792576
  buffer_load_dwordx4 v17, s[48:51], s33 offen lds
  s_mov_b32 m0, 157696
  s_add_u32 s33, s45, 880640
  buffer_load_dwordx4 v17, s[48:51], s33 offen lds
  s_mov_b32 m0, 158720
  s_add_u32 s33, s45, 968704
  buffer_load_dwordx4 v17, s[48:51], s33 offen lds
  s_mov_b32 m0, 159744
  s_add_u32 s33, s45, 1056768
  buffer_load_dwordx4 v17, s[48:51], s33 offen lds
  s_mov_b32 m0, 160768
  s_add_u32 s33, s45, 1144832
  buffer_load_dwordx4 v17, s[48:51], s33 offen lds
  s_mov_b32 m0, 161792
  s_add_u32 s33, s45, 1232896
  buffer_load_dwordx4 v17, s[48:51], s33 offen lds
  s_mov_b32 m0, 162816
  s_add_u32 s33, s45, 1320960
  buffer_load_dwordx4 v17, s[48:51], s33 offen lds
  s_waitcnt vmcnt(16)
  s_branch K_now
K_job2:
  s_sub_u32 s45, s61, 87
  s_cmp_ge_u32 s45, 32
  s_cbranch_scc1 K_now
  s_mov_b32 s48, s16
  s_mov_b32 s49, s17
  s_mov_b32 s50, 1409024
  s_mov_b32 s51, 0x20000
  s_lshl_b32 s45, s45, 5
  v_lshrrev_b32 v18, 1, v1
  v_lshlrev_b32 v18, 10, v18
  v_and_b32 v17, 1, v1
  v_lshl_add_u32 v17, v17, 4, v18
  s_mov_b32 s38, 800000
K_wd7b:
  ds_read_b32 v4, v19 offset:8800
  s_waitcnt lgkmcnt(0)
  v_cmp_ne_u32 vcc, 0, v4
  s_cmp_eq_u64 vcc, exec
  s_cbranch_scc1 K_wd7b_ok
  s_sleep 4
  s_sub_u32 s38, s38, 1
  s_cmp_lg_u32 s38, 0
  s_cbranch_scc1 K_wd7b
K_wd7b_ok:
  s_mov_b32 m0, 131072
  s_add_u32 s33, s45, 0
  buffer_load_dwordx4 v17, s[48:51], s33 offen lds
  s_mov_b32 m0, 132096
  s_add_u32 s33, s45, 32768
  buffer_load_dwordx4 v17, s[48:51], s33 offen lds
  s_mov_b32 m0, 133120
  s_add_u32 s33, s45, 65536
  buffer_load_dwordx4 v17, s[48:51], s33 offen lds
  s_mov_b32 m0, 134144
  s_add_u32 s33, s45, 98304
  buffer_load_dwordx4 v17, s[48:51], s33 offen lds
  s_mov_b32 m0, 135168
  s_add_u32 s33, s45, 131072
  buffer_load_dwordx4 v17, s[48:51], s33 offen lds
  s_mov_b32 m0, 136192
  s_add_u32 s33, s45, 163840
  buffer_load_dwordx4 v17, s[48:51], s33 offen lds
  s_mov_b32 m0, 137216
  s_add_u32 s33, s45, 196608
  buffer_load_dwordx4 v17, s[48:51], s33 offen lds
  s_mov_b32 m0, 138240
  s_add_u32 s33, s45, 229376
  buffer_load_dwordx4 v17, s[48:51], s33 offen lds
  s_mov_b32 m0, 139264
  s_add_u32 s33, s45, 262144
  buffer_load_dwordx4 v17, s[48:51], s33 offen lds
  s_mov_b32 m0, 140288
  s_add_u32 s33, s45, 294912
  buffer_load_dwordx4 v17, s[48:51], s33 offen lds
  s_mov_b32 m0, 141312
  s_add_u32 s33, s45, 327680
  buffer_load_dwordx4 v17, s[48:51], s33 offen lds
  s_mov_b32 m0, 142336
  s_add_u32 s33, s45, 360448
  buffer_load_dwordx4 v17, s[48:51], s33 offen lds
  s_mov_b32 m0, 143360
  s_add_u32 s33, s45, 393216
  buffer_load_dwordx4 v17, s[48:51], s33 offen lds
  s_mov_b32 m0, 144384
  s_add_u32 s33, s45, 425984
  buffer_load_dwordx4 v17, s[48:51], s33 offen lds
  s_mov_b32 m0, 145408
  s_add_u32 s33, s45, 458752
  buffer_load_dwordx4 v17, s[48:51], s33 offen lds
  s_mov_b32 m0, 146432
  s_add_u32 s33, s45, 491520
  buffer_load_dwordx4 v17, s[48:51], s33 offen lds
  s_waitcnt vmcnt(16)
  s_mov_b32 s38, 800000
K_wd8b:
  ds_read_b32 v4, v19 offset:8832
  s_waitcnt lgkmcnt(0)
  v_cmp_ne_u32 vcc, 0, v4
  s_cmp_eq_u64 vcc, exec
  s_cbranch_scc1 K_wd8b_ok
  s_sleep 4
  s_sub_u32 s38, s38, 1
  s_cmp_lg_u32 s38, 0
  s_cbranch_scc1 K_wd8b
K_wd8b_ok:
  s_mov_b32 m0, 147456
  s_add_u32 s33, s45, 524288
  buffer_load_dwordx4 v17, s[48:51], s33 offen lds
  s_mov_b32 m0, 148480
  s_add_u32 s33, s45, 557056
  buffer_load_dwordx4 v17, s[48:51], s33 offen lds
  s_mov_b32 m0, 149504
  s_add_u32 s33, s45, 589824
  buffer_load_dwordx4 v17, s[48:51], s33 offen lds
  s_mov_b32 m0, 150528
  s_add_u32 s33, s45, 622592
  buffer_load_dwordx4 v17, s[48:51], s33 offen lds
  s_mov_b32 m0, 151552
  s_add_u32 s33, s45, 655360
  buffer_load_dwordx4 v17, s[48:51], s33 offen lds
  s_mov_b32 m0, 152576
  s_add_u32 s33, s45, 688128
  buffer_load_dwordx4 v17, s[48:51], s33 offen lds
  s_mov_b32 m0, 153600
  s_add_u32 s33, s45, 720896
  buffer_load_dwordx4 v17, s[48:51], s33 offen lds
  s_mov_b32 m0, 154624
  s_add_u32 s33, s45, 753664
  buffer_load_dwordx4 v17, s[48:51], s33 offen lds
  s_mov_b32 m0, 155648
  s_add_u32 s33, s45, 786432
  buffer_load_dwordx4 v17, s[48:51], s33 offen lds
  s_mov_b32 m0, 156672
  s_add_u32 s33, s45, 819200
  buffer_load_dwordx4 v17, s[48:51], s33 offen lds
  s_mov_b32 m0, 157696
  s_add_u32 s33, s45, 851968
  buffer_load_dwordx4 v17, s[48:51], s33 offen lds
  s_mov_b32 m0, 158720
  s_add_u32 s33, s45, 884736
  buffer_load_dwordx4 v17, s[48:51], s33 offen lds
  s_mov_b32 m0, 159744
  s_add_u32 s33, s45, 917504
  buffer_load_dwordx4 v17, s[48:51], s33 offen lds
  s_mov_b32 m0, 160768
  s_add_u32 s33, s45, 950272
  buffer_load_dwordx4 v17, s[48:51], s33 offen lds
  s_mov_b32 m0, 161792
  s_add_u32 s33, s45, 983040
  buffer_load_dwordx4 v17, s[48:51], s33 offen lds
  s_mov_b32 m0, 162816
  s_add_u32 s33, s45, 1015808
  buffer_load_dwordx4 v17, s[48:51], s33 offen lds
  s_waitcnt vmcnt(16)
  s_mov_b32 s38, 800000
K_wd9b:
  ds_read_b32 v4, v19 offset:8864
  s_waitcnt lgkmcnt(0)
  v_cmp_ne_u32 vcc, 0, v4
  s_cmp_eq_u64 vcc, exec
  s_cbranch_scc1 K_wd9b_ok
  s_sleep 4
  s_sub_u32 s38, s38, 1
  s_cmp_lg_u32 s38, 0
  s_cbranch_scc1 K_wd9b
K_wd9b_ok:
  s_mov_b32 m0, 16384
  s_add_u32 s33, s45, 1048576
  buffer_load_dwordx4 v17, s[48:51], s33 offen lds
  s_mov_b32 m0, 17408
  s_add_u32 s33, s45, 1081344
  buffer_load_dwordx4 v17, s[48:51], s33 offen lds
  s_mov_b32 m0, 18432
  s_add_u32 s33, s45, 1114112
  buffer_load_dwordx4 v17, s[48:51], s33 offen lds
  s_mov_b32 m0, 19456
  s_add_u32 s33, s45, 1146880
  buffer_load_dwordx4 v17, s[48:51], s33 offen lds
  s_mov_b32 m0, 20480
  s_add_u32 s33, s45, 1179648
  buffer_load_dwordx4 v17, s[48:51], s33 offen lds
  s_mov_b32 m0, 21504
  s_add_u32 s33, s45, 1212416
  buffer_load_dwordx4 v17, s[48:51], s33 offen lds
  s_mov_b32 m0, 22528
  s_add_u32 s33, s45, 1245184
  buffer_load_dwordx4 v17, s[48:51], s33 offen lds
  s_mov_b32 m0, 23552
  s_add_u32 s33, s45, 1277952
  buffer_load_dwordx4 v17, s[48:51], s33 offen lds
  s_mov_b32 m0, 24576
  s_add_u32 s33, s45, 1310720
  buffer_load_dwordx4 v17, s[48:51], s33 offen lds
  s_mov_b32 m0, 25600
  s_add_u32 s33, s45, 1343488
  buffer_load_dwordx4 v17, s[48:51], s33 offen lds
  s_mov_b32 m0, 26624
  s_add_u32 s33, s45, 1376256
  buffer_load_dwordx4 v17, s[48:51], s33 offen lds
  s_waitcnt vmcnt(16)
K_now:
  s_waitcnt vmcnt(0)
  ds_write_b32 v8, v15 offset:9092
  s_mov_b32 s48, s8
  s_mov_b32 s49, s9
  s_mov_b32 s50, 524288
  s_mov_b32 s51, 0x20000
  s_lshl_b32 s45, s41, 7
  s_mov_b32 s38, 800000
K_wd10:
  ds_read_b32 v4, v19 offset:8896
  s_waitcnt lgkmcnt(0)
  v_cmp_ne_u32 vcc, 0, v4
  s_cmp_eq_u64 vcc, exec
  s_cbranch_scc1 K_wd10_ok
  s_sleep 4
  s_sub_u32 s38, s38, 1
  s_cmp_lg_u32 s38, 0
  s_cbranch_scc1 K_wd10
K_wd10_ok:
  s_mov_b32 m0, 32768
  s_add_u32 s33, s45, 0
  buffer_load_dwordx4 v16, s[48:51], s33 offen lds
  s_mov_b32 m0, 33792
  s_add_u32 s33, s45, 8192
  buffer_load_dwordx4 v16, s[48:51], s33 offen lds
  s_mov_b32 m0, 34816
  s_add_u32 s33, s45, 32768
  buffer_load_dwordx4 v16, s[48:51], s33 offen lds
  s_mov_b32 m0, 35840
  s_add_u32 s33, s45, 40960
  buffer_load_dwordx4 v16, s[48:51], s33 offen lds
  s_mov_b32 m0, 36864
  s_add_u32 s33, s45, 65536
  buffer_load_dwordx4 v16, s[48:51], s33 offen lds
  s_mov_b32 m0, 37888
  s_add_u32 s33, s45, 73728
  buffer_load_dwordx4 v16, s[48:51], s33 offen lds
  s_mov_b32 m0, 38912
  s_add_u32 s33, s45, 98304
  buffer_load_dwordx4 v16, s[48:51], s33 offen lds
  s_mov_b32 m0, 39936
  s_add_u32 s33, s45, 106496
  buffer_load_dwordx4 v16, s[48:51], s33 offen lds
  s_mov_b32 m0, 40960
  s_add_u32 s33, s45, 131072
  buffer_load_dwordx4 v16, s[48:51], s33 offen lds
  s_mov_b32 m0, 41984
  s_add_u32 s33, s45, 139264
  buffer_load_dwordx4 v16, s[48:51], s33 offen lds
  s_mov_b32 m0, 43008
  s_add_u32 s33, s45, 163840
  buffer_load_dwordx4 v16, s[48:51], s33 offen lds
  s_mov_b32 m0, 44032
  s_add_u32 s33, s45, 172032
  buffer_load_dwordx4 v16, s[48:51], s33 offen lds
  s_mov_b32 m0, 45056
  s_add_u32 s33, s45, 196608
  buffer_load_dwordx4 v16, s[48:51], s33 offen lds
  s_mov_b32 m0, 46080
  s_add_u32 s33, s45, 204800
  buffer_load_dwordx4 v16, s[48:51], s33 offen lds
  s_mov_b32 m0, 47104
  s_add_u32 s33, s45, 229376
  buffer_load_dwordx4 v16, s[48:51], s33 offen lds
  s_mov_b32 m0, 48128
  s_add_u32 s33, s45, 237568
  buffer_load_dwordx4 v16, s[48:51], s33 offen lds
  s_mov_b32 s38, 800000
K_wd11:
  ds_read_b32 v4, v19 offset:8928
  s_waitcnt lgkmcnt(0)
  v_cmp_ne_u32 vcc, 0, v4
  s_cmp_eq_u64 vcc, exec
  s_cbranch_scc1 K_wd11_ok
  s_sleep 4
  s_sub_u32 s38, s38, 1
  s_cmp_lg_u32 s38, 0
  s_cbranch_scc1 K_wd11
K_wd11_ok:
  s_mov_b32 m0, 49152
  s_add_u32 s33, s45, 262144
  buffer_load_dwordx4 v16, s[48:51], s33 offen lds
  s_mov_b32 m0, 50176
  s_add_u32 s33, s45, 270336
  buffer_load_dwordx4 v16, s[48:51], s33 offen lds
  s_mov_b32 m0, 51200
  s_add_u32 s33, s45, 294912
  buffer_load_dwordx4 v16, s[48:51], s33 offen lds
  s_mov_b32 m0, 52224
  s_add_u32 s33, s45, 303104
  buffer_load_dwordx4 v16, s[48:51], s33 offen lds
  s_mov_b32 m0, 53248
  s_add_u32 s33, s45, 327680
  buffer_load_dwordx4 v16, s[48:51], s33 offen lds
  s_mov_b32 m0, 54272
  s_add_u32 s33, s45, 335872
  buffer_load_dwordx4 v16, s[48:51], s33 offen lds
  s_mov_b32 m0, 55296
  s_add_u32 s33, s45, 360448
  buffer_load_dwordx4 v16, s[48:51], s33 offen lds
  s_mov_b32 m0, 56320
  s_add_u32 s33, s45, 368640
  buffer_load_dwordx4 v16, s[48:51], s33 offen lds
  s_mov_b32 m0, 57344
  s_add_u32 s33, s45, 393216
  buffer_load_dwordx4 v16, s[48:51], s33 offen lds
  s_mov_b32 m0, 58368
  s_add_u32 s33, s45, 401408
  buffer_load_dwordx4 v16, s[48:51], s33 offen lds
  s_mov_b32 m0, 59392
  s_add_u32 s33, s45, 425984
  buffer_load_dwordx4 v16, s[48:51], s33 offen lds
  s_mov_b32 m0, 60416
  s_add_u32 s33, s45, 434176
  buffer_load_dwordx4 v16, s[48:51], s33 offen lds
  s_mov_b32 m0, 61440
  s_add_u32 s33, s45, 458752
  buffer_load_dwordx4 v16, s[48:51], s33 offen lds
  s_mov_b32 m0, 62464
  s_add_u32 s33, s45, 466944
  buffer_load_dwordx4 v16, s[48:51], s33 offen lds
  s_mov_b32 m0, 63488
  s_add_u32 s33, s45, 491520
  buffer_load_dwordx4 v16, s[48:51], s33 offen lds
  s_mov_b32 m0, 64512
  s_add_u32 s33, s45, 499712
  buffer_load_dwordx4 v16, s[48:51], s33 offen lds
  s_waitcnt vmcnt(0)
  ds_write_b32 v8, v15 offset:9088
  s_mov_b32 s38, 800000
K_wd12:
  ds_read_b32 v4, v19 offset:8960
  s_waitcnt lgkmcnt(0)
  v_cmp_ne_u32 vcc, 0, v4
  s_cmp_eq_u64 vcc, exec
  s_cbranch_scc1 K_wd12_ok
  s_sleep 4
  s_sub_u32 s38, s38, 1
  s_cmp_lg_u32 s38, 0
  s_cbranch_scc1 K_wd12
K_wd12_ok:
  s_mov_b32 m0, 65536
  s_add_u32 s33, s45, 16384
  buffer_load_dwordx4 v16, s[48:51], s33 offen lds
  s_mov_b32 m0, 66560
  s_add_u32 s33, s45, 24576
  buffer_load_dwordx4 v16, s[48:51], s33 offen lds
  s_mov_b32 m0, 67584
  s_add_u32 s33, s45, 49152
  buffer_load_dwordx4 v16, s[48:51], s33 offen lds
  s_mov_b32 m0, 68608
  s_add_u32 s33, s45, 57344
  buffer_load_dwordx4 v16, s[48:51], s33 offen lds
  s_mov_b32 m0, 69632
  s_add_u32 s33, s45, 81920
  buffer_load_dwordx4 v16, s[48:51], s33 offen lds
  s_mov_b32 m0, 70656
  s_add_u32 s33, s45, 90112
  buffer_load_dwordx4 v16, s[48:51], s33 offen lds
  s_mov_b32 m0, 71680
  s_add_u32 s33, s45, 114688
  buffer_load_dwordx4 v16, s[48:51], s33 offen lds
  s_mov_b32 m0, 72704
  s_add_u32 s33, s45, 122880
  buffer_load_dwordx4 v16, s[48:51], s33 offen lds
  s_mov_b32 m0, 73728
  s_add_u32 s33, s45, 147456
  buffer_load_dwordx4 v16, s[48:51], s33 offen lds
  s_mov_b32 m0, 74752
  s_add_u32 s33, s45, 155648
  buffer_load_dwordx4 v16, s[48:51], s33 offen lds
  s_mov_b32 m0, 75776
  s_add_u32 s33, s45, 180224
  buffer_load_dwordx4 v16, s[48:51], s33 offen lds
  s_mov_b32 m0, 76800
  s_add_u32 s33, s45, 188416
  buffer_load_dwordx4 v16, s[48:51], s33 offen lds
  s_mov_b32 m0, 77824
  s_add_u32 s33, s45, 212992
  buffer_load_dwordx4 v16, s[48:51], s33 offen lds
  s_mov_b32 m0, 78848
  s_add_u32 s33, s45, 221184
  buffer_load_dwordx4 v16, s[48:51], s33 offen lds
  s_mov_b32 m0, 79872
  s_add_u32 s33, s45, 245760
  buffer_load_dwordx4 v16, s[48:51], s33 offen lds
  s_mov_b32 m0, 80896
  s_add_u32 s33, s45, 253952
  buffer_load_dwordx4 v16, s[48:51], s33 offen lds
  s_mov_b32 s38, 800000
K_wd13:
  ds_read_b32 v4, v19 offset:8992
  s_waitcnt lgkmcnt(0)
  v_cmp_ne_u32 vcc, 0, v4
  s_cmp_eq_u64 vcc, exec
  s_cbranch_scc1 K_wd13_ok
  s_sleep 4
  s_sub_u32 s38, s38, 1
  s_cmp_lg_u32 s38, 0
  s_cbranch_scc1 K_wd13
K_wd13_ok:
  s_mov_b32 m0, 81920
  s_add_u32 s33, s45, 278528
  buffer_load_dwordx4 v16, s[48:51], s33 offen lds
  s_mov_b32 m0, 82944
  s_add_u32 s33, s45, 286720
  buffer_load_dwordx4 v16, s[48:51], s33 offen lds
  s_mov_b32 m0, 83968
  s_add_u32 s33, s45, 311296
  buffer_load_dwordx4 v16, s[48:51], s33 offen lds
  s_mov_b32 m0, 84992
  s_add_u32 s33, s45, 319488
  buffer_load_dwordx4 v16, s[48:51], s33 offen lds
  s_mov_b32 m0, 86016
  s_add_u32 s33, s45, 344064
  buffer_load_dwordx4 v16, s[48:51], s33 offen lds
  s_mov_b32 m0, 87040
  s_add_u32 s33, s45, 352256
  buffer_load_dwordx4 v16, s[48:51], s33 offen lds
  s_mov_b32 m0, 88064
  s_add_u32 s33, s45, 376832
  buffer_load_dwordx4 v16, s[48:51], s33 offen lds
  s_mov_b32 m0, 89088
  s_add_u32 s33, s45, 385024
  buffer_load_dwordx4 v16, s[48:51], s33 offen lds
  s_mov_b32 m0, 90112
  s_add_u32 s33, s45, 409600
  buffer_load_dwordx4 v16, s[48:51], s33 offen lds
  s_mov_b32 m0, 91136
  s_add_u32 s33, s45, 417792
  buffer_load_dwordx4 v16, s[48:51], s33 offen lds
  s_mov_b32 m0, 92160
  s_add_u32 s33, s45, 442368
  buffer_load_dwordx4 v16, s[48:51], s33 offen lds
  s_mov_b32 m0, 93184
  s_add_u32 s33, s45, 450560
  buffer_load_dwordx4 v16, s[48:51], s33 offen lds
  s_mov_b32 m0, 94208
  s_add_u32 s33, s45, 475136
  buffer_load_dwordx4 v16, s[48:51], s33 offen lds
  s_mov_b32 m0, 95232
  s_add_u32 s33, s45, 483328
  buffer_load_dwordx4 v16, s[48:51], s33 offen lds
  s_mov_b32 m0, 96256
  s_add_u32 s33, s45, 507904
  buffer_load_dwordx4 v16, s[48:51], s33 offen lds
  s_mov_b32 m0, 97280
  s_add_u32 s33, s45, 516096
  buffer_load_dwordx4 v16, s[48:51], s33 offen lds
  s_waitcnt vmcnt(0)
  ds_write_b32 v8, v15 offset:9096
  v_mov_b32 v15, 1
  s_lshl_b32 s45, s40, 13
  s_add_u32 s45, s45, 12845056
  s_add_u32 s46, s45, 4096
  v_and_b32 v19, 1, v1
  v_lshlrev_b32 v19, 9, v19
  s_mov_b32 s38, 1600000
K_stxw:
  ds_read_b32 v4, v19 offset:9484
  s_waitcnt lgkmcnt(0)
  v_cmp_ne_u32 vcc, 0, v4
  s_cmp_eq_u64 vcc, exec
  s_cbranch_scc1 K_stxw_ok
  s_sleep 2
  s_sub_u32 s38, s38, 1
  s_cmp_lg_u32 s38, 0
  s_cbranch_scc1 K_stxw
K_stxw_ok:
  s_mov_b32 s38, 200000
K_pgr:
  buffer_load_dwordx4 v[64:67], v6, s[24:27], s45 offen offset:0 sc1
  buffer_load_dwordx4 v[68:71], v6, s[24:27], s45 offen offset:1024 sc1
  buffer_load_dwordx4 v[72:75], v6, s[24:27], s45 offen offset:2048 sc1
  buffer_load_dwordx4 v[76:79], v6, s[24:27], s45 offen offset:3072 sc1
  buffer_load_dwordx4 v[80:83], v6, s[24:27], s46 offen offset:0 sc1
  buffer_load_dwordx4 v[84:87], v6, s[24:27], s46 offen offset:1024 sc1
  buffer_load_dwordx4 v[88:91], v6, s[24:27], s46 offen offset:2048 sc1
  buffer_load_dwordx4 v[92:95], v6, s[24:27], s46 offen offset:3072 sc1
  s_waitcnt vmcnt(0)
  v_mov_b32 v4, 1
  v_and_b32 v18, v64, v65
  v_and_b32 v4, v4, v66
  v_and_b32 v4, v4, v18
  v_and_b32 v18, v68, v69
  v_and_b32 v4, v4, v70
  v_and_b32 v4, v4, v18
  v_and_b32 v18, v72, v73
  v_and_b32 v4, v4, v74
  v_and_b32 v4, v4, v18
  v_and_b32 v18, v76, v77
  v_and_b32 v4, v4, v78
  v_and_b32 v4, v4, v18
  v_and_b32 v18, v80, v81
  v_and_b32 v4, v4, v82
  v_and_b32 v4, v4, v18
  v_and_b32 v18, v84, v85
  v_and_b32 v4, v4, v86
  v_and_b32 v4, v4, v18
  v_and_b32 v18, v88, v89
  v_and_b32 v4, v4, v90
  v_and_b32 v4, v4, v18
  v_and_b32 v18, v92, v93
  v_and_b32 v4, v4, v94
  v_and_b32 v4, v4, v18
  v_cmp_ne_u32 vcc, 0, v4
  s_cmp_eq_u64 vcc, exec
  s_cbranch_scc1 K_pgr_ok
  s_sub_u32 s38, s38, 1
  s_cmp_lg_u32 s38, 0
  s_cbranch_scc1 K_pgr
K_pgr_ok:
  v_add_f32 v64, v64, v68
  v_add_f32 v72, v72, v76
  v_add_f32 v80, v80, v84
  v_add_f32 v88, v88, v92
  v_add_f32 v64, v64, v72
  v_add_f32 v80, v80, v88
  v_add_f32 v64, v64, v80
  v_add_f32 v65, v65, v69
  v_add_f32 v73, v73, v77
  v_add_f32 v81, v81, v85
  v_add_f32 v89, v89, v93
  v_add_f32 v65, v65, v73
  v_add_f32 v81, v81, v89
  v_add_f32 v65, v65, v81
  v_add_f32 v66, v66, v70
  v_add_f32 v74, v74, v78
  v_add_f32 v82, v82, v86
  v_add_f32 v90, v90, v94
  v_add_f32 v66, v66, v74
  v_add_f32 v82, v82, v90
  v_add_f32 v66, v66, v82
  v_mul_f32 v64, 0x3b000000, v64
  v_mul_f32 v65, 0x3b000000, v65
  v_fma_f32 v65, -v64, v64, v65
  v_max_f32 v65, 0, v65
  v_cvt_pk_bf16_f32 v64, v64, v64
  v_lshlrev_b32 v64, 16, v64
  v_cvt_pk_bf16_f32 v65, v65, v65
  v_lshlrev_b32 v65, 16, v65
  v_add_f32 v65, 0x3727c5ac, v65
  v_cvt_pk_bf16_f32 v65, v65, v65
  v_lshlrev_b32 v65, 16, v65
  v_sqrt_f32 v65, v65
  s_nop 0
  v_cvt_pk_bf16_f32 v65, v65, v65
  v_lshlrev_b32 v65, 16, v65
  v_rcp_f32 v65, v65
  s_nop 0
  v_fma_f32 v66, -v64, v20, v66
  v_mul_f32 v66, v66, v65
  v_or_b32 v64, 1, v64
  v_or_b32 v65, 1, v65
  v_lshlrev_b32 v18, 3, v1
  ds_write_b64 v18, v[64:65] offset:14592
  v_ashrrev_i32 v18, 31, v66
  v_or_b32 v18, 0x80000000, v18
  v_xor_b32 v66, v66, v18
  s_lshl_b32 s3, s40, 6
  s_sub_u32 s3, 2047, s3
  v_sub_u32 v18, s3, v1
  s_mov_b32 s3, 0xfffff800
  v_and_or_b32 v40, v66, s3, v18
  v_max_u32 v40, 1, v40
  s_nop 1
  v_mov_b32_dpp v41, v40 quad_perm:[1,0,3,2] row_mask:0xf bank_mask:0xf
  v_max_u32 v55, v40, v41
  v_min_u32 v41, v40, v41
  s_nop 1
  v_mov_b32_dpp v42, v41 quad_perm:[2,3,0,1] row_mask:0xf bank_mask:0xf
  v_mov_b32_dpp v43, v55 quad_perm:[2,3,0,1] row_mask:0xf bank_mask:0xf
  v_max_u32 v40, v55, v42
  v_min_u32 v42, v55, v42
  v_max_u32 v55, v41, v43
  v_min_u32 v43, v41, v43
  v_max_u32 v41, v40, v55
  v_min_u32 v55, v40, v55
  v_max_u32 v40, v42, v43
  v_min_u32 v43, v42, v43
  s_nop 1
  v_mov_b32_dpp v44, v43 row_half_mirror row_mask:0xf bank_mask:0xf
  v_mov_b32_dpp v45, v40 row_half_mirror row_mask:0xf bank_mask:0xf
  v_mov_b32_dpp v46, v55 row_half_mirror row_mask:0xf bank_mask:0xf
  v_mov_b32_dpp v47, v41 row_half_mirror row_mask:0xf bank_mask:0xf
  v_max_u32 v42, v41, v44
  v_min_u32 v44, v41, v44
  v_max_u32 v41, v55, v45
  v_min_u32 v45, v55, v45
  v_max_u32 v55, v40, v46
  v_min_u32 v46, v40, v46
  v_max_u32 v40, v43, v47
  v_min_u32 v47, v43, v47
  v_max_u32 v43, v42, v55
  v_min_u32 v55, v42, v55
  v_max_u32 v42, v41, v40
  v_min_u32 v40, v41, v40
  v_max_u32 v41, v44, v46
  v_min_u32 v46, v44, v46
  v_max_u32 v44, v45, v47
  v_min_u32 v47, v45, v47
  v_max_u32 v45, v43, v42
  v_min_u32 v42, v43, v42
  v_max_u32 v43, v55, v40
  v_min_u32 v40, v55, v40
  v_max_u32 v55, v41, v44
  v_min_u32 v44, v41, v44
  v_max_u32 v41, v46, v47
  v_min_u32 v47, v46, v47
  s_nop 1
  v_max_u32_dpp v48, v47, v45 row_mirror row_mask:0xf bank_mask:0xf
  v_max_u32_dpp v49, v41, v42 row_mirror row_mask:0xf bank_mask:0xf
  v_max_u32_dpp v50, v44, v43 row_mirror row_mask:0xf bank_mask:0xf
  v_max_u32_dpp v51, v55, v40 row_mirror row_mask:0xf bank_mask:0xf
  v_max_u32_dpp v52, v40, v55 row_mirror row_mask:0xf bank_mask:0xf
  v_max_u32_dpp v53, v43, v44 row_mirror row_mask:0xf bank_mask:0xf
  v_max_u32_dpp v54, v42, v41 row_mirror row_mask:0xf bank_mask:0xf
  v_max_u32_dpp v46, v45, v47 row_mirror row_mask:0xf bank_mask:0xf
  v_max_u32 v47, v48, v52
  v_min_u32 v52, v48, v52
  v_max_u32 v48, v49, v53
  v_min_u32 v53, v49, v53
  v_max_u32 v49, v50, v54
  v_min_u32 v54, v50, v54
  v_max_u32 v50, v51, v46
  v_min_u32 v46, v51, v46
  v_max_u32 v51, v47, v49
  v_min_u32 v49, v47, v49
  v_max_u32 v47, v48, v50
  v_min_u32 v50, v48, v50
  v_max_u32 v48, v52, v54
  v_min_u32 v54, v52, v54
  v_max_u32 v52, v53, v46
  v_min_u32 v46, v53, v46
  v_max_u32 v53, v51, v47
  v_min_u32 v47, v51, v47
  v_max_u32 v51, v49, v50
  v_min_u32 v50, v49, v50
  v_max_u32 v49, v48, v52
  v_min_u32 v52, v48, v52
  v_max_u32 v48, v54, v46
  v_min_u32 v46, v54, v46
  v_mov_b32 v45, v53
  v_mov_b32 v42, v47
  v_mov_b32 v43, v51
  v_mov_b32 v40, v50
  v_mov_b32 v55, v49
  v_mov_b32 v44, v52
  v_mov_b32 v41, v48
  v_mov_b32 v54, v46
  s_nop 0
  v_permlane16_swap_b32 v53, v45
  v_permlane16_swap_b32 v47, v42
  v_permlane16_swap_b32 v51, v43
  v_permlane16_swap_b32 v50, v40
  v_permlane16_swap_b32 v49, v55
  v_permlane16_swap_b32 v52, v44
  v_permlane16_swap_b32 v48, v41
  v_permlane16_swap_b32 v46, v54
  s_nop 0
  v_max_u32 v53, v53, v54
  v_max_u32 v47, v47, v41
  v_max_u32 v51, v51, v44
  v_max_u32 v50, v50, v55
  v_max_u32 v49, v49, v40
  v_max_u32 v52, v52, v43
  v_max_u32 v48, v48, v42
  v_max_u32 v46, v46, v45
  v_max_u32 v54, v53, v49
  v_min_u32 v49, v53, v49
  v_max_u32 v53, v47, v52
  v_min_u32 v52, v47, v52
  v_max_u32 v47, v51, v48
  v_min_u32 v48, v51, v48
  v_max_u32 v51, v50, v46
  v_min_u32 v46, v50, v46
  v_max_u32 v50, v54, v47
  v_min_u32 v47, v54, v47
  v_max_u32 v54, v53, v51
  v_min_u32 v51, v53, v51
  v_max_u32 v53, v49, v48
  v_min_u32 v48, v49, v48
  v_max_u32 v49, v52, v46
  v_min_u32 v46, v52, v46
  v_max_u32 v52, v50, v54
  v_min_u32 v54, v50, v54
  v_max_u32 v50, v47, v51
  v_min_u32 v51, v47, v51
  v_max_u32 v47, v53, v49
  v_min_u32 v49, v53, v49
  v_max_u32 v53, v48, v46
  v_min_u32 v46, v48, v46
  v_mov_b32 v45, v52
  v_mov_b32 v42, v54
  v_mov_b32 v43, v50
  v_mov_b32 v40, v51
  v_mov_b32 v55, v47
  v_mov_b32 v44, v49
  v_mov_b32 v41, v53
  v_mov_b32 v48, v46
  s_nop 0
  v_permlane32_swap_b32 v52, v45
  v_permlane32_swap_b32 v54, v42
  v_permlane32_swap_b32 v50, v43
  v_permlane32_swap_b32 v51, v40
  v_permlane32_swap_b32 v47, v55
  v_permlane32_swap_b32 v49, v44
  v_permlane32_swap_b32 v53, v41
  v_permlane32_swap_b32 v46, v48
  s_nop 0
  v_max_u32 v52, v52, v48
  v_max_u32 v54, v54, v41
  v_max_u32 v50, v50, v44
  v_max_u32 v51, v51, v55
  v_max_u32 v47, v47, v40
  v_max_u32 v49, v49, v43
  v_max_u32 v53, v53, v42
  v_max_u32 v46, v46, v45
  v_max_u32 v48, v52, v47
  v_min_u32 v47, v52, v47
  v_max_u32 v52, v54, v49
  v_min_u32 v49, v54, v49
  v_max_u32 v54, v50, v53
  v_min_u32 v53, v50, v53
  v_max_u32 v50, v51, v46
  v_min_u32 v46, v51, v46
  v_max_u32 v51, v48, v54
  v_min_u32 v54, v48, v54
  v_max_u32 v48, v52, v50
  v_min_u32 v50, v52, v50
  v_max_u32 v52, v47, v53
  v_min_u32 v53, v47, v53
  v_max_u32 v47, v49, v46
  v_min_u32 v46, v49, v46
  v_max_u32 v49, v51, v48
  v_min_u32 v48, v51, v48
  v_max_u32 v51, v54, v50
  v_min_u32 v50, v54, v50
  v_max_u32 v54, v52, v47
  v_min_u32 v47, v52, v47
  v_max_u32 v52, v53, v46
  v_min_u32 v46, v53, v46
  s_mov_b32 s3, 0xffffc7ff
  v_mov_b32 v18, 14336
  v_and_or_b32 v49, v49, s3, v18
  v_mov_b32 v18, 12288
  v_and_or_b32 v48, v48, s3, v18
  v_mov_b32 v18, 10240
  v_and_or_b32 v51, v51, s3, v18
  v_mov_b32 v18, 8192
  v_and_or_b32 v50, v50, s3, v18
  v_mov_b32 v18, 6144
  v_and_or_b32 v54, v54, s3, v18
  v_mov_b32 v18, 4096
  v_and_or_b32 v47, v47, s3, v18
  v_mov_b32 v18, 2048
  v_and_or_b32 v52, v52, s3, v18
  v_mov_b32 v18, 0
  v_and_or_b32 v46, v46, s3, v18
  v_max_u32 v46, 1, v46
  v_and_b32 v18, 1, v1
  v_cmp_eq_u32 vcc, 1, v18
  v_lshrrev_b32 v68, 1, v1
  v_lshlrev_b32 v68, 11, v68
  v_lshl_add_u32 v68, v18, 4, v68
  v_cndmask_b32 v72, v49, v54, vcc
  v_cndmask_b32 v73, v48, v47, vcc
  v_cndmask_b32 v74, v51, v52, vcc
  v_cndmask_b32 v75, v50, v46, vcc
  s_lshl_b32 s45, s40, 6
  s_add_u32 s45, s45, 13434880
  s_cmp_lg_u32 s41, 0
  s_cbranch_scc1 K_nopubc
  s_mov_b64 exec, 0xffff
  buffer_store_dwordx4 v[72:75], v68, s[24:27], s45 offen sc1
K_nopubc:
  s_mov_b64 exec, 3
  s_waitcnt lgkmcnt(0)
  ds_write_b128 v6, v[72:75] offset:15104
  s_mov_b64 exec, -1
K_nogr:
  v_and_b32 v19, 31, v1
  v_lshlrev_b32 v19, 6, v19
  s_and_b32 s45, s2, 7
  s_lshl_b32 s45, s45, 11
  s_add_u32 s45, s45, 13434880
  s_cmp_ge_u32 s61, 119
  s_cbranch_scc1 K_slowc
  s_mov_b32 s38, 200000
K_pc1:
  buffer_load_dwordx4 v[40:43], v19, s[24:27], s45 offen sc1
  buffer_load_dwordx4 v[44:47], v19, s[24:27], s45 offen offset:16 sc1
  s_waitcnt vmcnt(0)
  v_min_u32 v4, v40, v41
  v_min3_u32 v4, v4, v42, v43
  v_min3_u32 v4, v4, v44, v45
  v_min3_u32 v4, v4, v46, v47
  v_cmp_ne_u32 vcc, 0, v4
  s_cmp_eq_u64 vcc, exec
  s_cbranch_scc1 K_pc1_ok
  s_sleep 2
  s_sub_u32 s38, s38, 1
  s_cmp_lg_u32 s38, 0
  s_cbranch_scc1 K_pc1
K_pc1_ok:
  s_branch K_gotc
K_slowc:
  s_mov_b32 s38, 200000
K_pc2:
  buffer_load_dwordx4 v[40:43], v19, s[24:27], s45 offen sc1
  buffer_load_dwordx4 v[44:47], v19, s[24:27], s45 offen offset:16 sc1
  s_waitcnt vmcnt(0)
  v_min_u32 v4, v40, v41
  v_min3_u32 v4, v4, v42, v43
  v_min3_u32 v4, v4, v44, v45
  v_min3_u32 v4, v4, v46, v47
  v_cmp_ne_u32 vcc, 0, v4
  s_cmp_eq_u64 vcc, exec
  s_cbranch_scc1 K_pc2_ok
  s_sleep 24
  s_sub_u32 s38, s38, 1
  s_cmp_lg_u32 s38, 0
  s_cbranch_scc1 K_pc2
K_pc2_ok:
K_gotc:
  s_nop 1
  v_max_u32_dpp v48, v47, v40 quad_perm:[1,0,3,2] row_mask:0xf bank_mask:0xf
  v_max_u32_dpp v49, v46, v41 quad_perm:[1,0,3,2] row_mask:0xf bank_mask:0xf
  v_max_u32_dpp v50, v45, v42 quad_perm:[1,0,3,2] row_mask:0xf bank_mask:0xf
  v_max_u32_dpp v51, v44, v43 quad_perm:[1,0,3,2] row_mask:0xf bank_mask:0xf
  v_max_u32_dpp v52, v43, v44 quad_perm:[1,0,3,2] row_mask:0xf bank_mask:0xf
  v_max_u32_dpp v53, v42, v45 quad_perm:[1,0,3,2] row_mask:0xf bank_mask:0xf
  v_max_u32_dpp v54, v41, v46 quad_perm:[1,0,3,2] row_mask:0xf bank_mask:0xf
  v_max_u32_dpp v55, v40, v47 quad_perm:[1,0,3,2] row_mask:0xf bank_mask:0xf
  v_max_u32 v47, v48, v52
  v_min_u32 v52, v48, v52
  v_max_u32 v48, v49, v53
  v_min_u32 v53, v49, v53
  v_max_u32 v49, v50, v54
  v_min_u32 v54, v50, v54
  v_max_u32 v50, v51, v55
  v_min_u32 v55, v51, v55
  v_max_u32 v51, v47, v49
  v_min_u32 v49, v47, v49
  v_max_u32 v47, v48, v50
  v_min_u32 v50, v48, v50
  v_max_u32 v48, v52, v54
  v_min_u32 v54, v52, v54
  v_max_u32 v52, v53, v55
  v_min_u32 v55, v53, v55
  v_max_u32 v53, v51, v47
  v_min_u32 v47, v51, v47
  v_max_u32 v51, v49, v50
  v_min_u32 v50, v49, v50
  v_max_u32 v49, v48, v52
  v_min_u32 v52, v48, v52
  v_max_u32 v48, v54, v55
  v_min_u32 v55, v54, v55
  s_nop 1
  v_max_u32_dpp v40, v55, v53 quad_perm:[2,3,0,1] row_mask:0xf bank_mask:0xf
  v_max_u32_dpp v41, v48, v47 quad_perm:[2,3,0,1] row_mask:0xf bank_mask:0xf
  v_max_u32_dpp v42, v52, v51 quad_perm:[2,3,0,1] row_mask:0xf bank_mask:0xf
  v_max_u32_dpp v43, v49, v50 quad_perm:[2,3,0,1] row_mask:0xf bank_mask:0xf
  v_max_u32_dpp v44, v50, v49 quad_perm:[2,3,0,1] row_mask:0xf bank_mask:0xf
  v_max_u32_dpp v45, v51, v52 quad_perm:[2,3,0,1] row_mask:0xf bank_mask:0xf
  v_max_u32_dpp v46, v47, v48 quad_perm:[2,3,0,1] row_mask:0xf bank_mask:0xf
  v_max_u32_dpp v54, v53, v55 quad_perm:[2,3,0,1] row_mask:0xf bank_mask:0xf
  v_max_u32 v55, v40, v44
  v_min_u32 v44, v40, v44
  v_max_u32 v40, v41, v45
  v_min_u32 v45, v41, v45
  v_max_u32 v41, v42, v46
  v_min_u32 v46, v42, v46
  v_max_u32 v42, v43, v54
  v_min_u32 v54, v43, v54
  v_max_u32 v43, v55, v41
  v_min_u32 v41, v55, v41
  v_max_u32 v55, v40, v42
  v_min_u32 v42, v40, v42
  v_max_u32 v40, v44, v46
  v_min_u32 v46, v44, v46
  v_max_u32 v44, v45, v54
  v_min_u32 v54, v45, v54
  v_max_u32 v45, v43, v55
  v_min_u32 v55, v43, v55
  v_max_u32 v43, v41, v42
  v_min_u32 v42, v41, v42
  v_max_u32 v41, v40, v44
  v_min_u32 v44, v40, v44
  v_max_u32 v40, v46, v54
  v_min_u32 v54, v46, v54
  s_nop 1
  v_max_u32_dpp v53, v54, v45 row_half_mirror row_mask:0xf bank_mask:0xf
  v_max_u32_dpp v47, v40, v55 row_half_mirror row_mask:0xf bank_mask:0xf
  v_max_u32_dpp v51, v44, v43 row_half_mirror row_mask:0xf bank_mask:0xf
  v_max_u32_dpp v50, v41, v42 row_half_mirror row_mask:0xf bank_mask:0xf
  v_max_u32_dpp v49, v42, v41 row_half_mirror row_mask:0xf bank_mask:0xf
  v_max_u32_dpp v52, v43, v44 row_half_mirror row_mask:0xf bank_mask:0xf
  v_max_u32_dpp v48, v55, v40 row_half_mirror row_mask:0xf bank_mask:0xf
  v_max_u32_dpp v46, v45, v54 row_half_mirror row_mask:0xf bank_mask:0xf
  v_max_u32 v54, v53, v49
  v_min_u32 v49, v53, v49
  v_max_u32 v53, v47, v52
  v_min_u32 v52, v47, v52
  v_max_u32 v47, v51, v48
  v_min_u32 v48, v51, v48
  v_max_u32 v51, v50, v46
  v_min_u32 v46, v50, v46
  v_max_u32 v50, v54, v47
  v_min_u32 v47, v54, v47
  v_max_u32 v54, v53, v51
  v_min_u32 v51, v53, v51
  v_max_u32 v53, v49, v48
  v_min_u32 v48, v49, v48
  v_max_u32 v49, v52, v46
  v_min_u32 v46, v52, v46
  v_max_u32 v52, v50, v54
  v_min_u32 v54, v50, v54
  v_max_u32 v50, v47, v51
  v_min_u32 v51, v47, v51
  v_max_u32 v47, v53, v49
  v_min_u32 v49, v53, v49
  v_max_u32 v53, v48, v46
  v_min_u32 v46, v48, v46
  s_nop 1
  v_max_u32_dpp v45, v46, v52 row_mirror row_mask:0xf bank_mask:0xf
  v_max_u32_dpp v55, v53, v54 row_mirror row_mask:0xf bank_mask:0xf
  v_max_u32_dpp v43, v49, v50 row_mirror row_mask:0xf bank_mask:0xf
  v_max_u32_dpp v42, v47, v51 row_mirror row_mask:0xf bank_mask:0xf
  v_max_u32_dpp v41, v51, v47 row_mirror row_mask:0xf bank_mask:0xf
  v_max_u32_dpp v44, v50, v49 row_mirror row_mask:0xf bank_mask:0xf
  v_max_u32_dpp v40, v54, v53 row_mirror row_mask:0xf bank_mask:0xf
  v_max_u32_dpp v48, v52, v46 row_mirror row_mask:0xf bank_mask:0xf
  v_max_u32 v46, v45, v41
  v_min_u32 v41, v45, v41
  v_max_u32 v45, v55, v44
  v_min_u32 v44, v55, v44
  v_max_u32 v55, v43, v40
  v_min_u32 v40, v43, v40
  v_max_u32 v43, v42, v48
  v_min_u32 v48, v42, v48
  v_max_u32 v42, v46, v55
  v_min_u32 v55, v46, v55
  v_max_u32 v46, v45, v43
  v_min_u32 v43, v45, v43
  v_max_u32 v45, v41, v40
  v_min_u32 v40, v41, v40
  v_max_u32 v41, v44, v48
  v_min_u32 v48, v44, v48
  v_max_u32 v44, v42, v46
  v_min_u32 v46, v42, v46
  v_max_u32 v42, v55, v43
  v_min_u32 v43, v55, v43
  v_max_u32 v55, v45, v41
  v_min_u32 v41, v45, v41
  v_max_u32 v45, v40, v48
  v_min_u32 v48, v40, v48
  v_mov_b32 v52, v44
  v_mov_b32 v54, v46
  v_mov_b32 v50, v42
  v_mov_b32 v51, v43
  v_mov_b32 v47, v55
  v_mov_b32 v49, v41
  v_mov_b32 v53, v45
  v_mov_b32 v40, v48
  s_nop 0
  v_permlane16_swap_b32 v44, v52
  v_permlane16_swap_b32 v46, v54
  v_permlane16_swap_b32 v42, v50
  v_permlane16_swap_b32 v43, v51
  v_permlane16_swap_b32 v55, v47
  v_permlane16_swap_b32 v41, v49
  v_permlane16_swap_b32 v45, v53
  v_permlane16_swap_b32 v48, v40
  s_nop 0
  v_max_u32 v64, v44, v40
  v_max_u32 v65, v46, v53
  v_max_u32 v66, v42, v49
  v_max_u32 v67, v43, v47
  v_max_u32 v68, v55, v51
  v_max_u32 v69, v41, v50
  v_max_u32 v70, v45, v54
  v_max_u32 v71, v48, v52
  ds_write_b128 v8, v[64:67] offset:9152
  ds_write_b128 v8, v[68:71] offset:9168
  s_waitcnt lgkmcnt(0)
K_end:
  s_endpgm
text_end:
.section .rodata,"a"
.p2align 6
.amdhsa_kernel sequential_preLN__mha_block__moe_arch_mod__prompt_kernel
  .amdhsa_next_free_vgpr 168
  .amdhsa_next_free_sgpr 100
  .amdhsa_accum_offset 168
  .amdhsa_group_segment_fixed_size 0
  .amdhsa_kernarg_size 88
  .amdhsa_user_sgpr_count 2
  .amdhsa_user_sgpr_kernarg_segment_ptr 1
  .amdhsa_system_sgpr_workgroup_id_x 1
.end_amdhsa_kernel
```
